```python
import torch

def _softmax(x, axis=-1):
    return torch.softmax(x, dim=axis)
def _gelu(x):
    return torch.nn.functional.gelu(x, approximate="tanh")
def _silu(x):
    return torch.nn.functional.silu(x)
def _sigmoid(x):
    return torch.sigmoid(x)
def _layernorm(x, axis=-1, eps=1e-5):
    m = x.mean(dim=axis, keepdim=True)
    v = x.var(dim=axis, keepdim=True, unbiased=False)
    return (x - m) / torch.sqrt(v + eps)
def _scatter_add(tgt, idx, src, axis=0):
    return tgt.clone().index_add_(axis, idx, src)
def _segment_sum(src, seg, n):
    out = torch.zeros((n,) + src.shape[1:], dtype=src.dtype)
    return out.index_add_(0, seg, src)
def _pad(x, pw):
    flat = tuple(v for pair in reversed(pw) for v in pair)
    return torch.nn.functional.pad(x, flat)

kernel_name = 'recurrent_scan__compressed_kv_cla__glu_gated_reglu__decode'

def setup_inputs():

    _w = (lambda a: (lambda t: t.to(torch.bfloat16) if t.is_floating_point() else t)(torch.as_tensor(a)))
    def _A_setup():
        B, H, Sq, Sk, D, M = 2, 32, 1, 8192, 128, 512
        Dc = 4 * D
        return {
            "x": _w((lambda *s: torch.randn(*s, dtype=torch.bfloat16) * 0.05)(B, Sq, M)),
            "c_kv": _w((lambda *s: torch.randn(*s, dtype=torch.bfloat16) * 1.6)(B, Sk, Dc)),
            "w_q": _w((lambda *s: torch.randn(*s, dtype=torch.bfloat16) * 1.6)(M, H, D) * (M ** -0.5)),
            "w_uk": _w((lambda *s: torch.randn(*s, dtype=torch.bfloat16) * 1.6)(Dc, H, D) * (Dc ** -0.5)),
            "w_uv": _w((lambda *s: torch.randn(*s, dtype=torch.bfloat16) * 1.6)(Dc, H, D) * (Dc ** -0.5)),
            "w_o": _w((lambda *s: torch.randn(*s, dtype=torch.bfloat16) * 1.6)(H, D, M) * ((H * D) ** -0.5)),
        }
    _A_in = _A_setup()

    def _B_setup():
        B, S, D, F = 2, 1, 512, 1792
        return {
            "x": _w((lambda *s: torch.randn(*s, dtype=torch.bfloat16) * 0.05)(B, S, D)),
            "W_gate": _w((lambda *s: torch.randn(*s, dtype=torch.bfloat16) * 0.2)(D, F) * (2.0 / D) ** 0.5),
            "W_up": _w((lambda *s: torch.randn(*s, dtype=torch.bfloat16) * 0.2)(D, F) * (2.0 / D) ** 0.5),
            "W_down": _w((lambda *s: torch.randn(*s, dtype=torch.bfloat16) * 0.2)(F, D) * (1.0 / F) ** 0.5),
        }
    _B_in = _B_setup()

    return {
        "A_x": _A_in["x"],
        "A_c_kv": _A_in["c_kv"],
        "A_w_q": _A_in["w_q"],
        "A_w_uk": _A_in["w_uk"],
        "A_w_uv": _A_in["w_uv"],
        "A_w_o": _A_in["w_o"],
        "B_x": _B_in["x"],
        "B_W_gate": _B_in["W_gate"],
        "B_W_up": _B_in["W_up"],
        "B_W_down": _B_in["W_down"],
    }

def reference(A_x, A_c_kv, A_w_q, A_w_uk, A_w_uv, A_w_o, B_x, B_W_gate, B_W_up, B_W_down):
    def _A_ref(x, c_kv, w_q, w_uk, w_uv, w_o):
        B, Sq, M = x.shape[0], x.shape[1], x.shape[2]
        Sk = c_kv.shape[1]
        H, D = w_q.shape[1], w_q.shape[2]
        q = torch.einsum("bqm,mhd->bhqd", x, w_q)
        k = torch.einsum("bkc,chd->bhkd", c_kv, w_uk)
        v = torch.einsum("bkc,chd->bhkd", c_kv, w_uv)
        scores = torch.einsum("bhqd,bhkd->bhqk", q, k) * (D ** -0.5)
        off = Sk - Sq
        qi = torch.arange(Sq)[:, None]
        kj = torch.arange(Sk)[None, :]
        cmask = kj <= (qi + off)
        scores = torch.where(cmask[None, None], scores, -1e9)
        p = _softmax(scores, axis=-1)
        ctx = torch.einsum("bhqk,bhkd->bhqd", p, v)
        return torch.einsum("bhqd,hdm->bqm", ctx, w_o)

    def _B_ref(x, W_gate, W_up, W_down):
        gate = torch.einsum("bsd,df->bsf", x, W_gate)
        up = torch.einsum("bsd,df->bsf", x, W_up)
        gate = gate * (lambda x, dt: x.to(dt))(gate > 0, gate.dtype)
        h = gate * up
        return torch.einsum("bsf,fd->bsd", h, W_down)

    x = A_x
    xn = _layernorm(x, axis=-1)
    s = _A_ref(xn, A_c_kv, A_w_q, A_w_uk, A_w_uv, A_w_o)
    g = _silu(_B_ref(xn, B_W_gate, B_W_up, B_W_down))
    return x + s * g
```

```asm
; @launch grid=(256,1,1) block=(512,1,1) lds=163840
.amdgcn_target "amdgcn-amd-amdhsa--gfx950"
.text
.globl recurrent_scan__compressed_kv_cla__glu_gated_reglu__decode_kernel
.p2align 8
.type recurrent_scan__compressed_kv_cla__glu_gated_reglu__decode_kernel,@function
recurrent_scan__compressed_kv_cla__glu_gated_reglu__decode_kernel:
    s_load_dwordx16 s[4:19], s[0:1], 0
    s_load_dwordx8 s[20:27], s[0:1], 64
    s_load_dwordx2 s[28:29], s[0:1], 96
    s_cmp_ge_u32 s2, 256
    s_cbranch_scc1 Lend
    s_and_b32 s54, s2, 7
    s_lshr_b32 s55, s2, 4
    s_lshl_b32 s55, s55, 3
    s_or_b32 s31, s54, s55
    v_lshrrev_b32 v2, 6, v0
    v_and_b32 v1, 63, v0
    v_readfirstlane_b32 s30, v2
    v_and_b32 v2, 15, v1
    v_lshrrev_b32 v3, 4, v1
    v_lshlrev_b32 v4, 4, v1
    s_bitcmp1_b32 s2, 3
    s_cbranch_scc1 Latt
    s_and_b32 s52, s31, 7
    s_lshl_b32 s52, s52, 2
    s_bfe_u32 s54, s31, 0x20003
    s_add_u32 s52, s52, s54
    s_lshr_b32 s53, s31, 5
    v_and_b32 v5, 8, v1
    v_lshlrev_b32 v5, 7, v5
    v_lshl_add_u32 v5, v3, 5, v5
    v_lshlrev_b32 v6, 17, v3
    v_lshl_add_u32 v6, v2, 4, v6
    v_xor_b32 v7, v2, v3
    v_lshlrev_b32 v61, 4, v7
    v_lshl_add_u32 v7, v3, 13, v61
    v_lshl_add_u32 v61, v2, 8, v61
    s_lshl_b32 s55, s30, 7
    s_lshl_b32 s62, s52, 8
    s_lshl_b32 s56, s30, 19
    s_add_u32 s56, s56, s62
    s_lshl_b32 s57, s53, 20
    s_lshl_b32 s59, s30, 17
    s_add_u32 s57, s57, s59
    s_add_u32 s57, s57, s62
    v_lshlrev_b32 v62, 15, v3
    v_lshl_add_u32 v62, v2, 4, v62
    s_lshl_b32 s63, s52, 10
    s_lshl_b32 s59, s53, 8
    s_add_u32 s63, s63, s59
    v_and_b32 v28, 1, v1
    v_cmp_eq_u32 vcc, 1, v28
    v_mov_b32 v28, 0xffff
    v_mov_b32 v29, 0xffff0000
    v_cndmask_b32 v28, v28, v29, vcc
    v_bfe_u32 v29, v1, 1, 2
    v_cmp_eq_u32 vcc, 0, v29
    s_nop 1
    v_cndmask_b32 v24, 0, v28, vcc
    v_cmp_eq_u32 vcc, 1, v29
    s_nop 1
    v_cndmask_b32 v25, 0, v28, vcc
    v_cmp_eq_u32 vcc, 2, v29
    s_nop 1
    v_cndmask_b32 v26, 0, v28, vcc
    v_cmp_eq_u32 vcc, 3, v29
    s_nop 1
    v_cndmask_b32 v27, 0, v28, vcc
    s_waitcnt lgkmcnt(0)
    s_load_dword s3, s[28:29], 229376
    s_mov_b32 s32, s4
    s_mov_b32 s33, s5
    s_mov_b32 s34, 2048
    s_mov_b32 s35, 0x20000
    buffer_load_dwordx4 v[8:11], v4, s[32:35], 0 offen
    buffer_load_dwordx4 v[12:15], v4, s[32:35], 0 offen offset:1024
    buffer_load_dwordx4 v[16:19], v5, s[32:35], s55 offen
    buffer_load_dwordx4 v[20:23], v5, s[32:35], s55 offen offset:16
    s_mov_b32 s36, s8
    s_mov_b32 s37, s9
    s_mov_b32 s38, 4194304
    s_mov_b32 s39, 0x20000
    s_mov_b32 s40, s10
    s_mov_b32 s41, s11
    s_mov_b32 s42, 4194304
    s_mov_b32 s43, 0x20000
    s_mov_b32 s48, s28
    s_mov_b32 s49, s29
    s_mov_b32 s50, 65536
    s_mov_b32 s51, 0x20000
    s_lshl_b32 s59, s30, 12
    s_add_u32 s59, s59, 65536
    v_add_u32 v61, s59, v61
    s_add_u32 m0, s59, 0
    v_xor_b32 v60, 0, v7
    buffer_load_dwordx4 v60, s[40:43], s57 offen nt lds
    s_add_u32 s57, s57, 32768
    s_add_u32 m0, s59, 1024
    v_xor_b32 v60, 64, v7
    buffer_load_dwordx4 v60, s[40:43], s57 offen nt lds
    s_add_u32 s57, s57, 32768
    s_add_u32 m0, s59, 2048
    v_xor_b32 v60, 128, v7
    buffer_load_dwordx4 v60, s[40:43], s57 offen nt lds
    s_add_u32 s57, s57, 32768
    s_add_u32 m0, s59, 3072
    v_xor_b32 v60, 192, v7
    buffer_load_dwordx4 v60, s[40:43], s57 offen nt lds
    s_waitcnt vmcnt(4) lgkmcnt(0)
    s_add_u32 s3, s3, 1
    s_add_u32 s96, s3, 0
    s_and_b32 s96, s96, 0xff
    s_add_u32 s97, s3, 53
    s_and_b32 s97, s97, 0xff
    s_add_u32 s98, s3, 106
    s_and_b32 s98, s98, 0xff
    s_add_u32 s99, s3, 159
    s_and_b32 s99, s99, 0xff
    v_lshlrev_b32 v252, 2, v2
    s_mov_b32 s60, 0x7f4a7c15
    s_mov_b32 s61, 0x9e3779b9
    v_lshrrev_b64 v[254:255], v252, s[60:61]
    v_xor_b32 v252, s3, v254
    v_bfe_u32 v248, v252, 0, 1
    v_bfe_u32 v249, v252, 1, 1
    v_bfe_u32 v250, v252, 2, 1
    v_bfe_u32 v251, v252, 3, 1
    v_lshlrev_b32 v32, 16, v8
    v_and_b32 v33, 0xffff0000, v8
    v_lshlrev_b32 v34, 16, v9
    v_and_b32 v35, 0xffff0000, v9
    v_lshlrev_b32 v36, 16, v10
    v_and_b32 v37, 0xffff0000, v10
    v_lshlrev_b32 v38, 16, v11
    v_and_b32 v39, 0xffff0000, v11
    v_lshlrev_b32 v40, 16, v12
    v_and_b32 v41, 0xffff0000, v12
    v_lshlrev_b32 v42, 16, v13
    v_and_b32 v43, 0xffff0000, v13
    v_lshlrev_b32 v44, 16, v14
    v_and_b32 v45, 0xffff0000, v14
    v_lshlrev_b32 v46, 16, v15
    v_and_b32 v47, 0xffff0000, v15
    v_add_f32 v48, v32, v33
    v_add_f32 v49, v40, v41
    v_add_f32 v48, v48, v34
    v_add_f32 v49, v49, v42
    v_add_f32 v48, v48, v35
    v_add_f32 v49, v49, v43
    v_add_f32 v48, v48, v36
    v_add_f32 v49, v49, v44
    v_add_f32 v48, v48, v37
    v_add_f32 v49, v49, v45
    v_add_f32 v48, v48, v38
    v_add_f32 v49, v49, v46
    v_add_f32 v48, v48, v39
    v_add_f32 v49, v49, v47
    s_nop 0
    v_add_f32_dpp v48, v48, v48 quad_perm:[1,0,3,2] row_mask:0xf bank_mask:0xf
    v_add_f32_dpp v49, v49, v49 quad_perm:[1,0,3,2] row_mask:0xf bank_mask:0xf
    s_nop 0
    v_add_f32_dpp v48, v48, v48 quad_perm:[2,3,0,1] row_mask:0xf bank_mask:0xf
    v_add_f32_dpp v49, v49, v49 quad_perm:[2,3,0,1] row_mask:0xf bank_mask:0xf
    s_nop 0
    v_add_f32_dpp v48, v48, v48 row_half_mirror row_mask:0xf bank_mask:0xf
    v_add_f32_dpp v49, v49, v49 row_half_mirror row_mask:0xf bank_mask:0xf
    s_nop 0
    v_add_f32_dpp v48, v48, v48 row_mirror row_mask:0xf bank_mask:0xf
    v_add_f32_dpp v49, v49, v49 row_mirror row_mask:0xf bank_mask:0xf
    v_mov_b32 v52, v48
    v_mov_b32 v53, v49
    s_nop 0
    v_permlane16_swap_b32 v48, v52
    v_permlane16_swap_b32 v49, v53
    v_add_f32 v48, v48, v52
    v_add_f32 v49, v49, v53
    v_mov_b32 v52, v48
    v_mov_b32 v53, v49
    s_nop 0
    v_permlane32_swap_b32 v48, v52
    v_permlane32_swap_b32 v49, v53
    v_add_f32 v48, v48, v52
    v_add_f32 v49, v49, v53
    v_mul_f32 v48, 0x3b000000, v48
    v_mul_f32 v49, 0x3b000000, v49
    v_sub_f32 v32, v32, v48
    v_sub_f32 v40, v40, v49
    v_sub_f32 v33, v33, v48
    v_sub_f32 v41, v41, v49
    v_sub_f32 v34, v34, v48
    v_sub_f32 v42, v42, v49
    v_sub_f32 v35, v35, v48
    v_sub_f32 v43, v43, v49
    v_sub_f32 v36, v36, v48
    v_sub_f32 v44, v44, v49
    v_sub_f32 v37, v37, v48
    v_sub_f32 v45, v45, v49
    v_sub_f32 v38, v38, v48
    v_sub_f32 v46, v46, v49
    v_sub_f32 v39, v39, v48
    v_sub_f32 v47, v47, v49
    v_mul_f32 v50, v32, v32
    v_mul_f32 v51, v40, v40
    v_fmac_f32 v50, v33, v33
    v_fmac_f32 v51, v41, v41
    v_fmac_f32 v50, v34, v34
    v_fmac_f32 v51, v42, v42
    v_fmac_f32 v50, v35, v35
    v_fmac_f32 v51, v43, v43
    v_fmac_f32 v50, v36, v36
    v_fmac_f32 v51, v44, v44
    v_fmac_f32 v50, v37, v37
    v_fmac_f32 v51, v45, v45
    v_fmac_f32 v50, v38, v38
    v_fmac_f32 v51, v46, v46
    v_fmac_f32 v50, v39, v39
    v_fmac_f32 v51, v47, v47
    s_nop 0
    v_add_f32_dpp v50, v50, v50 quad_perm:[1,0,3,2] row_mask:0xf bank_mask:0xf
    v_add_f32_dpp v51, v51, v51 quad_perm:[1,0,3,2] row_mask:0xf bank_mask:0xf
    s_nop 0
    v_add_f32_dpp v50, v50, v50 quad_perm:[2,3,0,1] row_mask:0xf bank_mask:0xf
    v_add_f32_dpp v51, v51, v51 quad_perm:[2,3,0,1] row_mask:0xf bank_mask:0xf
    s_nop 0
    v_add_f32_dpp v50, v50, v50 row_half_mirror row_mask:0xf bank_mask:0xf
    v_add_f32_dpp v51, v51, v51 row_half_mirror row_mask:0xf bank_mask:0xf
    s_nop 0
    v_add_f32_dpp v50, v50, v50 row_mirror row_mask:0xf bank_mask:0xf
    v_add_f32_dpp v51, v51, v51 row_mirror row_mask:0xf bank_mask:0xf
    v_mov_b32 v52, v50
    v_mov_b32 v53, v51
    s_nop 0
    v_permlane16_swap_b32 v50, v52
    v_permlane16_swap_b32 v51, v53
    v_add_f32 v50, v50, v52
    v_add_f32 v51, v51, v53
    v_mov_b32 v52, v50
    v_mov_b32 v53, v51
    s_nop 0
    v_permlane32_swap_b32 v50, v52
    v_permlane32_swap_b32 v51, v53
    v_add_f32 v50, v50, v52
    v_add_f32 v51, v51, v53
    v_mov_b32 v52, 0x3727c5ac
    v_mov_b32 v53, 0x3b000000
    v_fma_f32 v50, v50, v53, v52
    v_fma_f32 v51, v51, v53, v52
    v_rsq_f32 v50, v50
    v_rsq_f32 v51, v51
    v_and_b32 v52, 8, v1
    v_cmp_ne_u32 vcc, 0, v52
    s_nop 1
    v_cndmask_b32 v30, v48, v49, vcc
    v_cndmask_b32 v31, v50, v51, vcc
    v_lshlrev_b32 v32, 16, v16
    v_and_b32 v33, 0xffff0000, v16
    v_lshlrev_b32 v34, 16, v17
    v_and_b32 v35, 0xffff0000, v17
    v_lshlrev_b32 v36, 16, v18
    v_and_b32 v37, 0xffff0000, v18
    v_lshlrev_b32 v38, 16, v19
    v_and_b32 v39, 0xffff0000, v19
    v_lshlrev_b32 v40, 16, v20
    v_and_b32 v41, 0xffff0000, v20
    v_lshlrev_b32 v42, 16, v21
    v_and_b32 v43, 0xffff0000, v21
    v_lshlrev_b32 v44, 16, v22
    v_and_b32 v45, 0xffff0000, v22
    v_lshlrev_b32 v46, 16, v23
    v_and_b32 v47, 0xffff0000, v23
    v_sub_f32 v32, v32, v30
    v_sub_f32 v33, v33, v30
    v_sub_f32 v34, v34, v30
    v_sub_f32 v35, v35, v30
    v_sub_f32 v36, v36, v30
    v_sub_f32 v37, v37, v30
    v_sub_f32 v38, v38, v30
    v_sub_f32 v39, v39, v30
    v_sub_f32 v40, v40, v30
    v_sub_f32 v41, v41, v30
    v_sub_f32 v42, v42, v30
    v_sub_f32 v43, v43, v30
    v_sub_f32 v44, v44, v30
    v_sub_f32 v45, v45, v30
    v_sub_f32 v46, v46, v30
    v_sub_f32 v47, v47, v30
    v_mul_f32 v32, v32, v31
    v_mul_f32 v33, v33, v31
    v_mul_f32 v34, v34, v31
    v_mul_f32 v35, v35, v31
    v_mul_f32 v36, v36, v31
    v_mul_f32 v37, v37, v31
    v_mul_f32 v38, v38, v31
    v_mul_f32 v39, v39, v31
    v_mul_f32 v40, v40, v31
    v_mul_f32 v41, v41, v31
    v_mul_f32 v42, v42, v31
    v_mul_f32 v43, v43, v31
    v_mul_f32 v44, v44, v31
    v_mul_f32 v45, v45, v31
    v_mul_f32 v46, v46, v31
    v_mul_f32 v47, v47, v31
    v_cvt_pk_bf16_f32 v32, v32, v32
    v_cvt_pk_bf16_f32 v33, v33, v33
    v_cvt_pk_bf16_f32 v34, v34, v34
    v_cvt_pk_bf16_f32 v35, v35, v35
    v_cvt_pk_bf16_f32 v36, v36, v36
    v_cvt_pk_bf16_f32 v37, v37, v37
    v_cvt_pk_bf16_f32 v38, v38, v38
    v_cvt_pk_bf16_f32 v39, v39, v39
    v_cvt_pk_bf16_f32 v40, v40, v40
    v_cvt_pk_bf16_f32 v41, v41, v41
    v_cvt_pk_bf16_f32 v42, v42, v42
    v_cvt_pk_bf16_f32 v43, v43, v43
    v_cvt_pk_bf16_f32 v44, v44, v44
    v_cvt_pk_bf16_f32 v45, v45, v45
    v_cvt_pk_bf16_f32 v46, v46, v46
    v_cvt_pk_bf16_f32 v47, v47, v47
    v_and_b32 v160, v32, v24
    v_and_b32 v161, v32, v25
    v_and_b32 v162, v32, v26
    v_and_b32 v163, v32, v27
    v_and_b32 v164, v33, v24
    v_and_b32 v165, v33, v25
    v_and_b32 v166, v33, v26
    v_and_b32 v167, v33, v27
    v_and_b32 v168, v34, v24
    v_and_b32 v169, v34, v25
    v_and_b32 v170, v34, v26
    v_and_b32 v171, v34, v27
    v_and_b32 v172, v35, v24
    v_and_b32 v173, v35, v25
    v_and_b32 v174, v35, v26
    v_and_b32 v175, v35, v27
    v_and_b32 v176, v36, v24
    v_and_b32 v177, v36, v25
    v_and_b32 v178, v36, v26
    v_and_b32 v179, v36, v27
    v_and_b32 v180, v37, v24
    v_and_b32 v181, v37, v25
    v_and_b32 v182, v37, v26
    v_and_b32 v183, v37, v27
    v_and_b32 v184, v38, v24
    v_and_b32 v185, v38, v25
    v_and_b32 v186, v38, v26
    v_and_b32 v187, v38, v27
    v_and_b32 v188, v39, v24
    v_and_b32 v189, v39, v25
    v_and_b32 v190, v39, v26
    v_and_b32 v191, v39, v27
    v_and_b32 v192, v40, v24
    v_and_b32 v193, v40, v25
    v_and_b32 v194, v40, v26
    v_and_b32 v195, v40, v27
    v_and_b32 v196, v41, v24
    v_and_b32 v197, v41, v25
    v_and_b32 v198, v41, v26
    v_and_b32 v199, v41, v27
    v_and_b32 v200, v42, v24
    v_and_b32 v201, v42, v25
    v_and_b32 v202, v42, v26
    v_and_b32 v203, v42, v27
    v_and_b32 v204, v43, v24
    v_and_b32 v205, v43, v25
    v_and_b32 v206, v43, v26
    v_and_b32 v207, v43, v27
    v_and_b32 v208, v44, v24
    v_and_b32 v209, v44, v25
    v_and_b32 v210, v44, v26
    v_and_b32 v211, v44, v27
    v_and_b32 v212, v45, v24
    v_and_b32 v213, v45, v25
    v_and_b32 v214, v45, v26
    v_and_b32 v215, v45, v27
    v_and_b32 v216, v46, v24
    v_and_b32 v217, v46, v25
    v_and_b32 v218, v46, v26
    v_and_b32 v219, v46, v27
    v_and_b32 v220, v47, v24
    v_and_b32 v221, v47, v25
    v_and_b32 v222, v47, v26
    v_and_b32 v223, v47, v27
    s_waitcnt vmcnt(0)
    s_barrier
    buffer_load_dwordx4 v[64:67], v6, s[36:39], s56 offen
    s_add_u32 s56, s56, 8192
    buffer_load_dwordx4 v[68:71], v6, s[36:39], s56 offen
    s_add_u32 s56, s56, 8192
    buffer_load_dwordx4 v[72:75], v6, s[36:39], s56 offen
    s_add_u32 s56, s56, 8192
    buffer_load_dwordx4 v[76:79], v6, s[36:39], s56 offen
    s_add_u32 s56, s56, 8192
    buffer_load_dwordx4 v[80:83], v6, s[36:39], s56 offen
    s_add_u32 s56, s56, 8192
    buffer_load_dwordx4 v[84:87], v6, s[36:39], s56 offen
    s_add_u32 s56, s56, 8192
    buffer_load_dwordx4 v[88:91], v6, s[36:39], s56 offen
    s_add_u32 s56, s56, 8192
    buffer_load_dwordx4 v[92:95], v6, s[36:39], s56 offen
    s_add_u32 s56, s56, 8192
    buffer_load_dwordx4 v[96:99], v6, s[36:39], s56 offen
    s_add_u32 s56, s56, 8192
    buffer_load_dwordx4 v[100:103], v6, s[36:39], s56 offen
    s_add_u32 s56, s56, 8192
    buffer_load_dwordx4 v[104:107], v6, s[36:39], s56 offen
    s_add_u32 s56, s56, 8192
    buffer_load_dwordx4 v[108:111], v6, s[36:39], s56 offen
    s_add_u32 s56, s56, 8192
    buffer_load_dwordx4 v[112:115], v6, s[36:39], s56 offen
    s_add_u32 s56, s56, 8192
    buffer_load_dwordx4 v[116:119], v6, s[36:39], s56 offen
    s_add_u32 s56, s56, 8192
    buffer_load_dwordx4 v[120:123], v6, s[36:39], s56 offen
    s_add_u32 s56, s56, 8192
    buffer_load_dwordx4 v[124:127], v6, s[36:39], s56 offen
    v_xor_b32 v60, 0, v61
    ds_read_b128 v[128:131], v60
    v_xor_b32 v60, 64, v61
    ds_read_b128 v[132:135], v60
    v_xor_b32 v60, 128, v61
    ds_read_b128 v[136:139], v60
    v_xor_b32 v60, 192, v61
    ds_read_b128 v[140:143], v60
    s_waitcnt vmcnt(15)
    v_mfma_f32_16x16x32_bf16 v[52:55], v[160:163], v[64:67], 0
    s_waitcnt vmcnt(14)
    v_mfma_f32_16x16x32_bf16 v[52:55], v[164:167], v[68:71], v[52:55]
    s_waitcnt vmcnt(13)
    v_mfma_f32_16x16x32_bf16 v[52:55], v[168:171], v[72:75], v[52:55]
    s_waitcnt vmcnt(12)
    v_mfma_f32_16x16x32_bf16 v[52:55], v[172:175], v[76:79], v[52:55]
    s_waitcnt vmcnt(11)
    v_mfma_f32_16x16x32_bf16 v[52:55], v[176:179], v[80:83], v[52:55]
    s_waitcnt vmcnt(10)
    v_mfma_f32_16x16x32_bf16 v[52:55], v[180:183], v[84:87], v[52:55]
    s_waitcnt vmcnt(9)
    v_mfma_f32_16x16x32_bf16 v[52:55], v[184:187], v[88:91], v[52:55]
    s_waitcnt vmcnt(8)
    v_mfma_f32_16x16x32_bf16 v[52:55], v[188:191], v[92:95], v[52:55]
    s_waitcnt vmcnt(7)
    v_mfma_f32_16x16x32_bf16 v[52:55], v[192:195], v[96:99], v[52:55]
    s_waitcnt vmcnt(6)
    v_mfma_f32_16x16x32_bf16 v[52:55], v[196:199], v[100:103], v[52:55]
    s_waitcnt vmcnt(5)
    v_mfma_f32_16x16x32_bf16 v[52:55], v[200:203], v[104:107], v[52:55]
    s_waitcnt vmcnt(4)
    v_mfma_f32_16x16x32_bf16 v[52:55], v[204:207], v[108:111], v[52:55]
    s_waitcnt vmcnt(3)
    v_mfma_f32_16x16x32_bf16 v[52:55], v[208:211], v[112:115], v[52:55]
    s_waitcnt vmcnt(2)
    v_mfma_f32_16x16x32_bf16 v[52:55], v[212:215], v[116:119], v[52:55]
    s_waitcnt vmcnt(1)
    v_mfma_f32_16x16x32_bf16 v[52:55], v[216:219], v[120:123], v[52:55]
    s_waitcnt vmcnt(0)
    v_mfma_f32_16x16x32_bf16 v[52:55], v[220:223], v[124:127], v[52:55]
    s_lshl_b32 s59, s30, 10
    v_add_u32 v8, s59, v4
    s_nop 5
    ds_write_b128 v8, v[52:55] offset:0
    s_lshl_b32 s59, s30, 9
    s_add_u32 s59, s59, 8192
    v_lshrrev_b32 v9, 5, v1
    v_lshlrev_b32 v9, 8, v9
    v_lshl_add_u32 v9, v2, 4, v9
    v_and_b32 v10, 1, v3
    v_lshl_add_u32 v9, v10, 3, v9
    v_add_u32 v9, s59, v9
    v_and_b32 v10, 1, v1
    v_lshlrev_b32 v10, 8, v10
    v_lshl_add_u32 v10, v3, 4, v10
    v_add_u32 v10, s59, v10
    s_waitcnt lgkmcnt(0)
    s_barrier
    ds_read_b128 v[64:67], v4 offset:0
    ds_read_b128 v[68:71], v4 offset:1024
    ds_read_b128 v[72:75], v4 offset:2048
    ds_read_b128 v[76:79], v4 offset:3072
    ds_read_b128 v[80:83], v4 offset:4096
    ds_read_b128 v[84:87], v4 offset:5120
    ds_read_b128 v[88:91], v4 offset:6144
    ds_read_b128 v[92:95], v4 offset:7168
    s_waitcnt lgkmcnt(6)
    v_pk_add_f32 v[64:65], v[64:65], v[68:69]
    v_pk_add_f32 v[66:67], v[66:67], v[70:71]
    s_waitcnt lgkmcnt(4)
    v_pk_add_f32 v[72:73], v[72:73], v[76:77]
    v_pk_add_f32 v[74:75], v[74:75], v[78:79]
    s_waitcnt lgkmcnt(2)
    v_pk_add_f32 v[80:81], v[80:81], v[84:85]
    v_pk_add_f32 v[82:83], v[82:83], v[86:87]
    s_waitcnt lgkmcnt(0)
    v_pk_add_f32 v[88:89], v[88:89], v[92:93]
    v_pk_add_f32 v[90:91], v[90:91], v[94:95]
    v_pk_add_f32 v[64:65], v[64:65], v[72:73]
    v_pk_add_f32 v[66:67], v[66:67], v[74:75]
    v_pk_add_f32 v[80:81], v[80:81], v[88:89]
    v_pk_add_f32 v[82:83], v[82:83], v[90:91]
    v_pk_add_f32 v[52:53], v[64:65], v[80:81]
    v_pk_add_f32 v[54:55], v[66:67], v[82:83]
    v_cvt_pk_bf16_f32 v52, v52, v53
    v_cvt_pk_bf16_f32 v53, v54, v55
    ds_write_b64 v9, v[52:53]
    ds_read_b128 v[64:67], v10 offset:0
    ds_read_b128 v[68:71], v10 offset:64
    ds_read_b128 v[72:75], v10 offset:128
    ds_read_b128 v[76:79], v10 offset:192
    s_waitcnt lgkmcnt(3)
    v_mfma_f32_16x16x32_bf16 v[56:59], v[128:131], v[64:67], 0
    s_waitcnt lgkmcnt(2)
    v_mfma_f32_16x16x32_bf16 v[56:59], v[132:135], v[68:71], v[56:59]
    s_waitcnt lgkmcnt(1)
    v_mfma_f32_16x16x32_bf16 v[56:59], v[136:139], v[72:75], v[56:59]
    s_waitcnt lgkmcnt(0)
    v_mfma_f32_16x16x32_bf16 v[56:59], v[140:143], v[76:79], v[56:59]
    s_mov_b32 s59, 0x3e0293ee
    s_lshl_b32 s58, s30, 5
    v_lshlrev_b32 v9, 8, v2
    v_lshl_add_u32 v9, v3, 3, v9
    v_add_u32 v9, s58, v9
    v_cmp_gt_u32 vcc, 2, v2
    s_nop 1
    v_mul_f32 v56, s59, v56
    v_mul_f32 v57, s59, v57
    v_mul_f32 v58, s59, v58
    v_mul_f32 v59, s59, v59
    v_cvt_pk_bf16_f32 v56, v56, v57
    v_cvt_pk_bf16_f32 v57, v58, v59
    s_and_saveexec_b64 s[60:61], vcc
    ds_write_b64 v9, v[56:57] offset:12288
    s_mov_b64 exec, s[60:61]
    s_waitcnt lgkmcnt(0)
    s_barrier
    s_cmp_lg_u32 s30, 0
    s_cbranch_scc1 Lq_done1
    ds_read_b128 v[8:11], v4 offset:12288
    v_mov_b32 v12, 0xfffffffe
    s_mov_b32 exec_hi, 0
    s_waitcnt lgkmcnt(0)
    v_and_or_b32 v8, v8, v12, v248
    v_and_or_b32 v9, v9, v12, v249
    v_and_or_b32 v10, v10, v12, v250
    v_and_or_b32 v11, v11, v12, v251
    buffer_store_dwordx4 v[8:11], v62, s[48:51], s63 offen sc1
    s_mov_b64 exec, -1
Lq_done1:
    s_cmp_ge_u32 s31, 56
    s_cselect_b32 s54, 1, 0
    s_mul_i32 s57, s54, 56
    s_sub_u32 s57, s31, s57
    s_lshr_b32 s55, s57, 2
    s_and_b32 s56, s57, 3
    v_and_b32 v5, 8, v1
    v_lshlrev_b32 v5, 7, v5
    v_lshl_add_u32 v5, v3, 3, v5
    v_mul_u32_u24 v6, 14336, v3
    v_lshl_add_u32 v6, v2, 4, v6
    s_lshl_b32 s57, s56, 7
    s_lshl_b32 s58, s30, 4
    s_add_u32 s57, s57, s58
    s_mul_i32 s58, s57, 3584
    s_lshl_b32 s59, s55, 8
    s_add_u32 s58, s58, s59
    s_lshl_b32 s57, s57, 1
    s_cmp_eq_u32 s54, 0
    s_cselect_b32 s36, s18, s20
    s_cselect_b32 s37, s19, s21
    s_mov_b32 s38, 1835008
    s_mov_b32 s39, 0x20000
    buffer_load_dwordx2 v[208:209], v5, s[32:35], s57 offen
    buffer_load_dwordx4 v[192:195], v6, s[36:39], s58 offen nt
    s_add_u32 s58, s58, 3584
    buffer_load_dwordx4 v[196:199], v6, s[36:39], s58 offen nt
    s_add_u32 s58, s58, 3584
    buffer_load_dwordx4 v[200:203], v6, s[36:39], s58 offen nt
    s_add_u32 s58, s58, 3584
    buffer_load_dwordx4 v[204:207], v6, s[36:39], s58 offen nt
    s_barrier
    s_mov_b32 s40, s12
    s_mov_b32 s41, s13
    s_mov_b32 s42, 4194304
    s_mov_b32 s43, 0x20000
    s_mov_b32 s44, s14
    s_mov_b32 s45, s15
    s_mov_b32 s46, 4194304
    s_mov_b32 s47, 0x20000
    v_lshlrev_b32 v8, 12, v3
    v_lshl_add_u32 v8, v2, 4, v8
    s_lshl_b32 s60, s52, 17
    s_lshl_b32 s59, s30, 14
    s_add_u32 s60, s60, s59
    s_add_u32 s59, s53, 0
    s_and_b32 s59, s59, 3
    s_lshl_b32 s59, s59, 8
    s_add_u32 s59, s59, s60
    buffer_load_dwordx4 v[128:131], v8, s[44:47], s59 offen offset:0
    buffer_load_dwordx4 v[144:147], v8, s[44:47], s59 offen offset:1024
    buffer_load_dwordx4 v[160:163], v8, s[44:47], s59 offen offset:2048
    buffer_load_dwordx4 v[176:179], v8, s[44:47], s59 offen offset:3072
    v_lshlrev_b32 v7, 15, v3
    v_lshl_add_u32 v7, v2, 4, v7
    s_lshl_b32 s58, s53, 20
    s_lshl_b32 s59, s30, 17
    s_add_u32 s58, s58, s59
    s_lshl_b32 s59, s52, 8
    s_add_u32 s58, s58, s59
    buffer_load_dwordx4 v[232:235], v7, s[40:43], s58 offen nt
    s_add_u32 s58, s58, 8192
    buffer_load_dwordx4 v[236:239], v7, s[40:43], s58 offen nt
    s_add_u32 s58, s58, 8192
    buffer_load_dwordx4 v[240:243], v7, s[40:43], s58 offen nt
    s_add_u32 s58, s58, 8192
    buffer_load_dwordx4 v[244:247], v7, s[40:43], s58 offen nt
    s_cmp_ge_u32 s31, 112
    s_cbranch_scc1 Lgu_done2
    s_cmp_ge_u32 s31, 56
    s_cselect_b32 s54, 1, 0
    s_mul_i32 s57, s54, 56
    s_sub_u32 s57, s31, s57
    s_lshr_b32 s55, s57, 2
    s_and_b32 s56, s57, 3
    s_waitcnt vmcnt(8)
    v_lshlrev_b32 v32, 16, v208
    v_and_b32 v33, 0xffff0000, v208
    v_lshlrev_b32 v34, 16, v209
    v_and_b32 v35, 0xffff0000, v209
    v_sub_f32 v32, v32, v30
    v_sub_f32 v33, v33, v30
    v_sub_f32 v34, v34, v30
    v_sub_f32 v35, v35, v30
    v_mul_f32 v32, v32, v31
    v_mul_f32 v33, v33, v31
    v_mul_f32 v34, v34, v31
    v_mul_f32 v35, v35, v31
    v_cvt_pk_bf16_f32 v32, v32, v32
    v_cvt_pk_bf16_f32 v33, v33, v33
    v_cvt_pk_bf16_f32 v34, v34, v34
    v_cvt_pk_bf16_f32 v35, v35, v35
    v_and_b32 v96, v32, v24
    v_and_b32 v97, v32, v25
    v_and_b32 v98, v32, v26
    v_and_b32 v99, v32, v27
    v_and_b32 v100, v33, v24
    v_and_b32 v101, v33, v25
    v_and_b32 v102, v33, v26
    v_and_b32 v103, v33, v27
    v_and_b32 v104, v34, v24
    v_and_b32 v105, v34, v25
    v_and_b32 v106, v34, v26
    v_and_b32 v107, v34, v27
    v_and_b32 v108, v35, v24
    v_and_b32 v109, v35, v25
    v_and_b32 v110, v35, v26
    v_and_b32 v111, v35, v27
    v_mfma_f32_16x16x32_bf16 v[52:55], v[96:99], v[192:195], 0
    v_mfma_f32_16x16x32_bf16 v[52:55], v[100:103], v[196:199], v[52:55]
    v_mfma_f32_16x16x32_bf16 v[52:55], v[104:107], v[200:203], v[52:55]
    v_mfma_f32_16x16x32_bf16 v[52:55], v[108:111], v[204:207], v[52:55]
    s_lshl_b32 s59, s30, 10
    v_add_u32 v11, s59, v4
    s_nop 5
    ds_write_b128 v11, v[52:55] offset:16384
    s_waitcnt lgkmcnt(0)
    s_barrier
    s_cmp_lg_u32 s30, 1
    s_cbranch_scc1 Lgu_done2
    ds_read_b128 v[64:67], v4 offset:16384
    ds_read_b128 v[68:71], v4 offset:17408
    ds_read_b128 v[72:75], v4 offset:18432
    ds_read_b128 v[76:79], v4 offset:19456
    ds_read_b128 v[80:83], v4 offset:20480
    ds_read_b128 v[84:87], v4 offset:21504
    ds_read_b128 v[88:91], v4 offset:22528
    ds_read_b128 v[92:95], v4 offset:23552
    s_waitcnt lgkmcnt(6)
    v_pk_add_f32 v[64:65], v[64:65], v[68:69]
    v_pk_add_f32 v[66:67], v[66:67], v[70:71]
    s_waitcnt lgkmcnt(4)
    v_pk_add_f32 v[72:73], v[72:73], v[76:77]
    v_pk_add_f32 v[74:75], v[74:75], v[78:79]
    s_waitcnt lgkmcnt(2)
    v_pk_add_f32 v[80:81], v[80:81], v[84:85]
    v_pk_add_f32 v[82:83], v[82:83], v[86:87]
    s_waitcnt lgkmcnt(0)
    v_pk_add_f32 v[88:89], v[88:89], v[92:93]
    v_pk_add_f32 v[90:91], v[90:91], v[94:95]
    v_pk_add_f32 v[64:65], v[64:65], v[72:73]
    v_pk_add_f32 v[66:67], v[66:67], v[74:75]
    v_pk_add_f32 v[80:81], v[80:81], v[88:89]
    v_pk_add_f32 v[82:83], v[82:83], v[90:91]
    v_pk_add_f32 v[52:53], v[64:65], v[80:81]
    v_pk_add_f32 v[54:55], v[66:67], v[82:83]
    s_add_u32 s36, s28, 786432
    s_addc_u32 s37, s29, 0
    s_mov_b32 s38, 114688
    s_mov_b32 s39, 0x20000
    v_lshrrev_b32 v9, 5, v1
    v_mul_u32_u24 v9, 14336, v9
    v_lshl_add_u32 v9, v2, 5, v9
    v_and_b32 v10, 1, v3
    v_lshl_add_u32 v9, v10, 4, v9
    s_mul_i32 s59, s56, 28672
    s_mul_i32 s57, s54, 7168
    s_add_u32 s59, s59, s57
    s_lshl_b32 s57, s55, 9
    s_add_u32 s59, s59, s57
    v_mov_b32 v10, 0xffffff00
    v_and_or_b32 v52, v52, v10, s96
    v_and_or_b32 v53, v53, v10, s97
    v_and_or_b32 v54, v54, v10, s98
    v_and_or_b32 v55, v55, v10, s99
    buffer_store_dwordx4 v[52:55], v9, s[36:39], s59 offen sc1
Lgu_done2:
    s_waitcnt vmcnt(4)
    s_add_u32 s59, s53, 1
    s_and_b32 s59, s59, 3
    s_lshl_b32 s59, s59, 8
    s_add_u32 s59, s59, s60
    buffer_load_dwordx4 v[132:135], v8, s[44:47], s59 offen offset:0
    buffer_load_dwordx4 v[148:151], v8, s[44:47], s59 offen offset:1024
    buffer_load_dwordx4 v[164:167], v8, s[44:47], s59 offen offset:2048
    buffer_load_dwordx4 v[180:183], v8, s[44:47], s59 offen offset:3072
    s_add_u32 s59, s53, 2
    s_and_b32 s59, s59, 3
    s_lshl_b32 s59, s59, 8
    s_add_u32 s59, s59, s60
    buffer_load_dwordx4 v[136:139], v8, s[44:47], s59 offen offset:0
    buffer_load_dwordx4 v[152:155], v8, s[44:47], s59 offen offset:1024
    buffer_load_dwordx4 v[168:171], v8, s[44:47], s59 offen offset:2048
    buffer_load_dwordx4 v[184:187], v8, s[44:47], s59 offen offset:3072
    s_add_u32 s59, s53, 3
    s_and_b32 s59, s59, 3
    s_lshl_b32 s59, s59, 8
    s_add_u32 s59, s59, s60
    buffer_load_dwordx4 v[140:143], v8, s[44:47], s59 offen offset:0
    buffer_load_dwordx4 v[156:159], v8, s[44:47], s59 offen offset:1024
    buffer_load_dwordx4 v[172:175], v8, s[44:47], s59 offen offset:2048
    buffer_load_dwordx4 v[188:191], v8, s[44:47], s59 offen offset:3072
    s_and_b32 s62, s30, 3
    s_lshr_b32 s63, s30, 2
    v_lshlrev_b32 v7, 8, v1
    s_lshl_b32 s56, s63, 14
    s_lshl_b32 s57, s52, 3
    s_add_u32 s56, s56, s57
    v_lshlrev_b32 v8, 10, v3
    v_lshl_add_u32 v8, v2, 4, v8
    s_lshl_b32 s57, s52, 2
    s_add_u32 s57, s57, s53
    s_lshl_b32 s57, s57, 15
    s_lshl_b32 s58, s63, 14
    s_add_u32 s57, s57, s58
    s_lshl_b32 s58, s62, 12
    s_add_u32 s57, s57, s58
    s_add_u32 s32, s28, 65536
    s_addc_u32 s33, s29, 0
    s_mov_b32 s34, 32768
    s_mov_b32 s35, 0x20000
    s_add_u32 s36, s28, 2097152
    s_addc_u32 s37, s29, 0
    s_mov_b32 s38, 4194304
    s_mov_b32 s39, 0x20000
    s_add_u32 s48, s28, 262144
    s_addc_u32 s49, s29, 0
    s_mov_b32 s50, 524288
    s_mov_b32 s51, 0x20000
    s_lshl_b32 s60, s62, 6
    v_lshlrev_b32 v12, 4, v3
    v_add_u32 v40, s60, v12
    v_add_u32 v41, 4, v40
    v_add_u32 v42, 8, v40
    v_add_u32 v43, 12, v40
    v_mul_u32_u24 v13, 288, v3
    v_lshl_add_u32 v13, v2, 4, v13
    s_mul_i32 s60, s30, 1152
    v_add_u32 v11, s60, v13
    v_bfe_u32 v14, v1, 3, 1
    v_and_b32 v16, 1, v3
    v_lshl_add_u32 v16, v14, 1, v16
    v_mul_u32_u24 v15, 288, v16
    v_lshrrev_b32 v16, 1, v3
    v_lshl_add_u32 v15, v16, 4, v15
    s_lshl_b32 s60, s30, 5
    v_add_u32 v15, s60, v15
    v_mul_u32_u24 v16, 4608, v14
    v_add_u32 v16, v16, v15
    v_cmp_eq_u32 s[58:59], s63, v14
    v_lshrrev_b32 v9, 5, v1
    v_lshlrev_b32 v9, 18, v9
    v_lshrrev_b32 v10, 2, v2
    v_lshl_add_u32 v9, v10, 14, v9
    v_and_b32 v10, 3, v2
    v_lshl_add_u32 v9, v10, 5, v9
    v_and_b32 v10, 1, v3
    v_lshl_add_u32 v9, v10, 4, v9
    s_lshl_b32 s61, s31, 7
    s_add_u32 s60, s62, s53
    s_and_b32 s60, s60, 3
    s_lshl_b32 s60, s60, 16
    s_add_u32 s61, s61, s60
    s_mul_i32 s60, s62, 9216
    s_add_u32 s60, s60, 98304
    v_add_u32 v17, s60, v13
    v_mov_b32 v10, 0xffffff00
    s_mov_b32 s100, 20000
Lspin3:
    buffer_load_dwordx2 v[18:19], v7, s[32:35], s56 offen sc1
    s_waitcnt vmcnt(0)
    v_xor_b32 v20, s96, v18
    v_xor_b32 v21, s97, v19
    v_or_b32 v20, v20, v21
    v_and_b32 v20, 0xff, v20
    v_cmp_ne_u32 vcc, 0, v20
    s_nop 1
    s_cmp_eq_u64 vcc, 0
    s_cbranch_scc1 Lspind3
    s_sub_u32 s100, s100, 1
    s_cmp_lg_u32 s100, 0
    s_cbranch_scc1 Lspin3
Lspind3:
    s_nop 0
    v_mov_b32 v20, v18
    s_nop 1
    v_max_f32_dpp v20, v20, v20 quad_perm:[1,0,3,2] row_mask:0xf bank_mask:0xf
    s_nop 1
    v_max_f32_dpp v20, v20, v20 quad_perm:[2,3,0,1] row_mask:0xf bank_mask:0xf
    s_nop 1
    v_max_f32_dpp v20, v20, v20 row_half_mirror row_mask:0xf bank_mask:0xf
    s_nop 1
    v_max_f32_dpp v20, v20, v20 row_mirror row_mask:0xf bank_mask:0xf
    v_mov_b32 v21, v20
    s_nop 1
    v_permlane16_swap_b32 v20, v21
    v_max_f32 v20, v20, v21
    v_mov_b32 v21, v20
    s_nop 1
    v_permlane32_swap_b32 v20, v21
    v_max_f32 v20, v20, v21
    v_sub_f32 v18, v18, v20
    v_exp_f32 v18, v18
    s_nop 0
    ds_bpermute_b32 v32, v40, v18
    ds_bpermute_b32 v33, v41, v18
    ds_bpermute_b32 v34, v42, v18
    ds_bpermute_b32 v35, v43, v18
    buffer_load_dwordx4 v[64:67], v8, s[36:39], s57 offen offset:0 sc1
    buffer_load_dwordx4 v[68:71], v8, s[36:39], s57 offen offset:256 sc1
    buffer_load_dwordx4 v[72:75], v8, s[36:39], s57 offen offset:512 sc1
    buffer_load_dwordx4 v[76:79], v8, s[36:39], s57 offen offset:768 sc1
    v_mul_f32 v19, v19, v18
    s_nop 1
    v_add_f32_dpp v19, v19, v19 quad_perm:[1,0,3,2] row_mask:0xf bank_mask:0xf
    s_nop 1
    v_add_f32_dpp v19, v19, v19 quad_perm:[2,3,0,1] row_mask:0xf bank_mask:0xf
    s_nop 1
    v_add_f32_dpp v19, v19, v19 row_half_mirror row_mask:0xf bank_mask:0xf
    s_nop 1
    v_add_f32_dpp v19, v19, v19 row_mirror row_mask:0xf bank_mask:0xf
    v_mov_b32 v21, v19
    s_nop 1
    v_permlane16_swap_b32 v19, v21
    v_add_f32 v19, v19, v21
    v_mov_b32 v21, v19
    s_nop 1
    v_permlane32_swap_b32 v19, v21
    v_add_f32 v19, v19, v21
    v_rcp_f32 v19, v19
    s_waitcnt lgkmcnt(0)
    v_cndmask_b32 v32, 0, v32, s[58:59]
    v_cndmask_b32 v33, 0, v33, s[58:59]
    v_cndmask_b32 v34, 0, v34, s[58:59]
    v_cndmask_b32 v35, 0, v35, s[58:59]
    v_cvt_pk_bf16_f32 v32, v32, v32
    v_cvt_pk_bf16_f32 v33, v33, v33
    v_cvt_pk_bf16_f32 v34, v34, v34
    v_cvt_pk_bf16_f32 v35, v35, v35
    v_and_b32 v80, v32, v24
    v_and_b32 v81, v32, v25
    v_and_b32 v82, v32, v26
    v_and_b32 v83, v32, v27
    v_and_b32 v84, v33, v24
    v_and_b32 v85, v33, v25
    v_and_b32 v86, v33, v26
    v_and_b32 v87, v33, v27
    v_and_b32 v88, v34, v24
    v_and_b32 v89, v34, v25
    v_and_b32 v90, v34, v26
    v_and_b32 v91, v34, v27
    v_and_b32 v92, v35, v24
    v_and_b32 v93, v35, v25
    v_and_b32 v94, v35, v26
    v_and_b32 v95, v35, v27
    s_mov_b32 s100, 20000
Lopv4:
    s_waitcnt vmcnt(0)
    v_xor_b32 v20, v248, v64
    v_xor_b32 v21, v249, v65
    v_xor_b32 v22, v250, v66
    v_or3_b32 v20, v20, v21, v22
    v_xor_b32 v21, v251, v67
    v_xor_b32 v22, v248, v68
    v_or3_b32 v20, v20, v21, v22
    v_xor_b32 v21, v249, v69
    v_xor_b32 v22, v250, v70
    v_or3_b32 v20, v20, v21, v22
    v_xor_b32 v21, v251, v71
    v_xor_b32 v22, v248, v72
    v_or3_b32 v20, v20, v21, v22
    v_xor_b32 v21, v249, v73
    v_xor_b32 v22, v250, v74
    v_or3_b32 v20, v20, v21, v22
    v_xor_b32 v21, v251, v75
    v_xor_b32 v22, v248, v76
    v_or3_b32 v20, v20, v21, v22
    v_xor_b32 v21, v249, v77
    v_xor_b32 v22, v250, v78
    v_or3_b32 v20, v20, v21, v22
    v_xor_b32 v21, v251, v79
    v_or_b32 v20, v20, v21
    v_and_b32 v20, 1, v20
    v_cmp_ne_u32 vcc, 0, v20
    s_nop 1
    s_cmp_eq_u64 vcc, 0
    s_cbranch_scc1 Lopd4
    s_sub_u32 s100, s100, 1
    s_cmp_eq_u32 s100, 0
    s_cbranch_scc1 Lopd4
    buffer_load_dwordx4 v[64:67], v8, s[36:39], s57 offen offset:0 sc1
    buffer_load_dwordx4 v[68:71], v8, s[36:39], s57 offen offset:256 sc1
    buffer_load_dwordx4 v[72:75], v8, s[36:39], s57 offen offset:512 sc1
    buffer_load_dwordx4 v[76:79], v8, s[36:39], s57 offen offset:768 sc1
    s_branch Lopv4
Lopd4:
    v_mfma_f32_16x16x32_bf16 v[52:55], v[80:83], v[64:67], 0
    v_mfma_f32_16x16x32_bf16 v[52:55], v[84:87], v[68:71], v[52:55]
    v_mfma_f32_16x16x32_bf16 v[52:55], v[88:91], v[72:75], v[52:55]
    v_mfma_f32_16x16x32_bf16 v[52:55], v[92:95], v[76:79], v[52:55]
    s_nop 7
    v_pk_mul_f32 v[52:53], v[52:53], v[18:19] op_sel:[0,1] op_sel_hi:[1,1]
    v_pk_mul_f32 v[54:55], v[54:55], v[18:19] op_sel:[0,1] op_sel_hi:[1,1]
    ds_write_b128 v11, v[52:55] offset:32768
    s_waitcnt lgkmcnt(0)
    s_barrier
    ds_read_b128 v[96:99], v16 offset:32768
    ds_read_b128 v[100:103], v16 offset:33920
    ds_read_b128 v[104:107], v16 offset:35072
    ds_read_b128 v[108:111], v16 offset:36224
    s_waitcnt lgkmcnt(2)
    v_pk_add_f32 v[96:97], v[96:97], v[100:101]
    v_pk_add_f32 v[98:99], v[98:99], v[102:103]
    s_waitcnt lgkmcnt(0)
    v_pk_add_f32 v[104:105], v[104:105], v[108:109]
    v_pk_add_f32 v[106:107], v[106:107], v[110:111]
    v_pk_add_f32 v[32:33], v[96:97], v[104:105]
    v_pk_add_f32 v[34:35], v[98:99], v[106:107]
    v_cvt_pk_bf16_f32 v32, v32, v32
    v_cvt_pk_bf16_f32 v33, v33, v33
    v_cvt_pk_bf16_f32 v34, v34, v34
    v_cvt_pk_bf16_f32 v35, v35, v35
    v_and_b32 v80, v32, v24
    v_and_b32 v81, v32, v25
    v_and_b32 v82, v32, v26
    v_and_b32 v83, v32, v27
    v_and_b32 v84, v33, v24
    v_and_b32 v85, v33, v25
    v_and_b32 v86, v33, v26
    v_and_b32 v87, v33, v27
    v_and_b32 v88, v34, v24
    v_and_b32 v89, v34, v25
    v_and_b32 v90, v34, v26
    v_and_b32 v91, v34, v27
    v_and_b32 v92, v35, v24
    v_and_b32 v93, v35, v25
    v_and_b32 v94, v35, v26
    v_and_b32 v95, v35, v27
    v_mfma_f32_16x16x32_bf16 v[52:55], v[80:83], v[232:235], 0
    v_mfma_f32_16x16x32_bf16 v[52:55], v[84:87], v[236:239], v[52:55]
    v_mfma_f32_16x16x32_bf16 v[52:55], v[88:91], v[240:243], v[52:55]
    v_mfma_f32_16x16x32_bf16 v[52:55], v[92:95], v[244:247], v[52:55]
    s_nop 7
    ds_write_b128 v11, v[52:55] offset:43008
    s_waitcnt lgkmcnt(0)
    s_barrier
    ds_read_b128 v[96:99], v15 offset:43008
    ds_read_b128 v[100:103], v15 offset:44160
    ds_read_b128 v[104:107], v15 offset:45312
    ds_read_b128 v[108:111], v15 offset:46464
    ds_read_b128 v[112:115], v15 offset:47616
    ds_read_b128 v[116:119], v15 offset:48768
    ds_read_b128 v[120:123], v15 offset:49920
    ds_read_b128 v[124:127], v15 offset:51072
    s_waitcnt lgkmcnt(6)
    v_pk_add_f32 v[96:97], v[96:97], v[100:101]
    v_pk_add_f32 v[98:99], v[98:99], v[102:103]
    s_waitcnt lgkmcnt(4)
    v_pk_add_f32 v[104:105], v[104:105], v[108:109]
    v_pk_add_f32 v[106:107], v[106:107], v[110:111]
    s_waitcnt lgkmcnt(2)
    v_pk_add_f32 v[112:113], v[112:113], v[116:117]
    v_pk_add_f32 v[114:115], v[114:115], v[118:119]
    s_waitcnt lgkmcnt(0)
    v_pk_add_f32 v[120:121], v[120:121], v[124:125]
    v_pk_add_f32 v[122:123], v[122:123], v[126:127]
    v_pk_add_f32 v[96:97], v[96:97], v[104:105]
    v_pk_add_f32 v[98:99], v[98:99], v[106:107]
    v_pk_add_f32 v[112:113], v[112:113], v[120:121]
    v_pk_add_f32 v[114:115], v[114:115], v[122:123]
    v_pk_add_f32 v[32:33], v[96:97], v[112:113]
    v_pk_add_f32 v[34:35], v[98:99], v[114:115]
    v_cvt_pk_bf16_f32 v32, v32, v32
    v_cvt_pk_bf16_f32 v33, v33, v33
    v_cvt_pk_bf16_f32 v34, v34, v34
    v_cvt_pk_bf16_f32 v35, v35, v35
    v_and_b32 v80, v32, v24
    v_and_b32 v81, v32, v25
    v_and_b32 v82, v32, v26
    v_and_b32 v83, v32, v27
    v_and_b32 v84, v33, v24
    v_and_b32 v85, v33, v25
    v_and_b32 v86, v33, v26
    v_and_b32 v87, v33, v27
    v_and_b32 v88, v34, v24
    v_and_b32 v89, v34, v25
    v_and_b32 v90, v34, v26
    v_and_b32 v91, v34, v27
    v_and_b32 v92, v35, v24
    v_and_b32 v93, v35, v25
    v_and_b32 v94, v35, v26
    v_and_b32 v95, v35, v27
    v_mfma_f32_16x16x32_bf16 v[64:67], v[80:83], v[128:131], 0
    v_mfma_f32_16x16x32_bf16 v[68:71], v[80:83], v[132:135], 0
    v_mfma_f32_16x16x32_bf16 v[72:75], v[80:83], v[136:139], 0
    v_mfma_f32_16x16x32_bf16 v[76:79], v[80:83], v[140:143], 0
    v_mfma_f32_16x16x32_bf16 v[64:67], v[84:87], v[144:147], v[64:67]
    v_mfma_f32_16x16x32_bf16 v[68:71], v[84:87], v[148:151], v[68:71]
    v_mfma_f32_16x16x32_bf16 v[72:75], v[84:87], v[152:155], v[72:75]
    v_mfma_f32_16x16x32_bf16 v[76:79], v[84:87], v[156:159], v[76:79]
    v_mfma_f32_16x16x32_bf16 v[64:67], v[88:91], v[160:163], v[64:67]
    v_mfma_f32_16x16x32_bf16 v[68:71], v[88:91], v[164:167], v[68:71]
    v_mfma_f32_16x16x32_bf16 v[72:75], v[88:91], v[168:171], v[72:75]
    v_mfma_f32_16x16x32_bf16 v[76:79], v[88:91], v[172:175], v[76:79]
    v_mfma_f32_16x16x32_bf16 v[64:67], v[92:95], v[176:179], v[64:67]
    v_mfma_f32_16x16x32_bf16 v[68:71], v[92:95], v[180:183], v[68:71]
    v_mfma_f32_16x16x32_bf16 v[72:75], v[92:95], v[184:187], v[72:75]
    v_mfma_f32_16x16x32_bf16 v[76:79], v[92:95], v[188:191], v[76:79]
    v_add_u32 v12, 98304, v11
    s_nop 3
    ds_write_b128 v12, v[64:67] offset:0
    ds_write_b128 v12, v[68:71] offset:9216
    ds_write_b128 v12, v[72:75] offset:18432
    ds_write_b128 v12, v[76:79] offset:27648
    s_waitcnt lgkmcnt(0)
    s_barrier
    s_cmp_ge_u32 s30, 4
    s_cbranch_scc1 Lpost_done5
    ds_read_b128 v[96:99], v17 offset:0
    ds_read_b128 v[100:103], v17 offset:1152
    ds_read_b128 v[104:107], v17 offset:2304
    ds_read_b128 v[108:111], v17 offset:3456
    ds_read_b128 v[112:115], v17 offset:4608
    ds_read_b128 v[116:119], v17 offset:5760
    ds_read_b128 v[120:123], v17 offset:6912
    ds_read_b128 v[124:127], v17 offset:8064
    s_waitcnt lgkmcnt(6)
    v_pk_add_f32 v[96:97], v[96:97], v[100:101]
    v_pk_add_f32 v[98:99], v[98:99], v[102:103]
    s_waitcnt lgkmcnt(4)
    v_pk_add_f32 v[104:105], v[104:105], v[108:109]
    v_pk_add_f32 v[106:107], v[106:107], v[110:111]
    s_waitcnt lgkmcnt(2)
    v_pk_add_f32 v[112:113], v[112:113], v[116:117]
    v_pk_add_f32 v[114:115], v[114:115], v[118:119]
    s_waitcnt lgkmcnt(0)
    v_pk_add_f32 v[120:121], v[120:121], v[124:125]
    v_pk_add_f32 v[122:123], v[122:123], v[126:127]
    v_pk_add_f32 v[96:97], v[96:97], v[104:105]
    v_pk_add_f32 v[98:99], v[98:99], v[106:107]
    v_pk_add_f32 v[112:113], v[112:113], v[120:121]
    v_pk_add_f32 v[114:115], v[114:115], v[122:123]
    v_pk_add_f32 v[52:53], v[96:97], v[112:113]
    v_pk_add_f32 v[54:55], v[98:99], v[114:115]
    v_and_or_b32 v52, v52, v10, s96
    v_and_or_b32 v53, v53, v10, s97
    v_and_or_b32 v54, v54, v10, s98
    v_and_or_b32 v55, v55, v10, s99
    buffer_store_dwordx4 v[52:55], v9, s[48:51], s61 offen sc1
Lpost_done5:
    s_endpgm
Latt:
    s_lshr_b32 s52, s31, 6
    v_and_b32 v6, 31, v1
    v_lshrrev_b32 v7, 5, v1
    v_lshlrev_b32 v60, 2, v7
    v_xor_b32 v60, v60, v6
    v_lshlrev_b32 v60, 4, v60
    v_lshl_add_u32 v60, v7, 10, v60
    s_lshr_b32 s54, s30, 1
    s_and_b32 s55, s30, 1
    s_lshl_b32 s56, s54, 15
    s_lshl_b32 s57, s55, 9
    s_add_u32 s56, s56, s57
    s_lshl_b32 s58, s55, 16
    s_lshl_b32 s59, s54, 14
    s_add_u32 s58, s58, s59
    s_lshl_b32 s59, s31, 17
    s_waitcnt lgkmcnt(0)
    s_load_dword s3, s[28:29], 229376
    s_mov_b32 s61, s56
    s_mov_b32 s40, s8
    s_mov_b32 s41, s9
    s_mov_b32 s42, 4194304
    s_mov_b32 s43, 0x20000
    s_mov_b32 s60, s58
    s_mov_b32 s62, s59
    s_lshr_b32 s58, s31, 3
    s_and_b32 s59, s31, 7
    s_lshl_b32 s58, s58, 3
    s_add_u32 s58, s58, s30
    s_lshl_b32 s58, s58, 15
    s_lshl_b32 s59, s59, 10
    s_add_u32 s58, s58, s59
    buffer_load_dwordx4 v[216:219], v4, s[40:43], s58 offen
    s_add_u32 s58, s58, 8192
    buffer_load_dwordx4 v[220:223], v4, s[40:43], s58 offen
    s_add_u32 s58, s58, 8192
    buffer_load_dwordx4 v[224:227], v4, s[40:43], s58 offen
    s_add_u32 s58, s58, 8192
    buffer_load_dwordx4 v[228:231], v4, s[40:43], s58 offen
    s_mov_b32 s58, s60
    s_mov_b32 s59, s62
    s_mov_b32 s56, s61
    s_and_b32 s55, s30, 1
    s_add_u32 s32, s6, s59
    s_addc_u32 s33, s7, 0
    s_mov_b32 s34, 131072
    s_mov_b32 s35, 0x20000
    s_add_u32 m0, s58, 0
    v_xor_b32 v61, 0, v60
    buffer_load_dwordx4 v61, s[32:35], s56 offen nt lds
    s_add_u32 s56, s56, 2048
    s_add_u32 m0, s58, 1024
    v_xor_b32 v61, 128, v60
    buffer_load_dwordx4 v61, s[32:35], s56 offen nt lds
    s_add_u32 s56, s56, 2048
    s_add_u32 m0, s58, 2048
    v_xor_b32 v61, 48, v60
    buffer_load_dwordx4 v61, s[32:35], s56 offen nt lds
    s_waitcnt vmcnt(0)
    s_add_u32 s56, s56, 2048
    s_add_u32 m0, s58, 3072
    v_xor_b32 v61, 176, v60
    buffer_load_dwordx4 v61, s[32:35], s56 offen nt lds
    s_add_u32 s56, s56, 2048
    s_add_u32 m0, s58, 4096
    v_xor_b32 v61, 32, v60
    buffer_load_dwordx4 v61, s[32:35], s56 offen nt lds
    s_add_u32 s56, s56, 2048
    s_add_u32 m0, s58, 5120
    v_xor_b32 v61, 160, v60
    buffer_load_dwordx4 v61, s[32:35], s56 offen nt lds
    s_add_u32 s56, s56, 2048
    s_add_u32 m0, s58, 6144
    v_xor_b32 v61, 16, v60
    buffer_load_dwordx4 v61, s[32:35], s56 offen nt lds
    s_add_u32 s56, s56, 2048
    s_add_u32 m0, s58, 7168
    v_xor_b32 v61, 144, v60
    buffer_load_dwordx4 v61, s[32:35], s56 offen nt lds
    s_add_u32 s56, s56, 2048
    s_add_u32 m0, s58, 8192
    v_xor_b32 v61, 0, v60
    buffer_load_dwordx4 v61, s[32:35], s56 offen nt lds
    s_add_u32 s56, s56, 2048
    s_add_u32 m0, s58, 9216
    v_xor_b32 v61, 128, v60
    buffer_load_dwordx4 v61, s[32:35], s56 offen nt lds
    s_add_u32 s56, s56, 2048
    s_add_u32 m0, s58, 10240
    v_xor_b32 v61, 48, v60
    buffer_load_dwordx4 v61, s[32:35], s56 offen nt lds
    s_add_u32 s56, s56, 2048
    s_add_u32 m0, s58, 11264
    v_xor_b32 v61, 176, v60
    buffer_load_dwordx4 v61, s[32:35], s56 offen nt lds
    s_add_u32 s56, s56, 2048
    s_add_u32 m0, s58, 12288
    v_xor_b32 v61, 32, v60
    buffer_load_dwordx4 v61, s[32:35], s56 offen nt lds
    s_add_u32 s56, s56, 2048
    s_add_u32 m0, s58, 13312
    v_xor_b32 v61, 160, v60
    buffer_load_dwordx4 v61, s[32:35], s56 offen nt lds
    s_add_u32 s56, s56, 2048
    s_add_u32 m0, s58, 14336
    v_xor_b32 v61, 16, v60
    buffer_load_dwordx4 v61, s[32:35], s56 offen nt lds
    s_add_u32 s56, s56, 2048
    s_add_u32 m0, s58, 15360
    v_xor_b32 v61, 144, v60
    buffer_load_dwordx4 v61, s[32:35], s56 offen nt lds
    v_lshlrev_b32 v212, 11, v3
    v_lshl_add_u32 v212, v2, 4, v212
    s_lshl_b32 s54, s31, 4
    s_lshr_b32 s56, s30, 2
    s_lshl_b32 s56, s56, 3
    s_add_u32 s54, s54, s56
    s_lshl_b32 s53, s54, 10
    s_and_b32 s57, s30, 3
    s_lshl_b32 s57, s57, 8
    s_add_u32 s53, s53, s57
    s_mov_b32 s32, s22
    s_mov_b32 s33, s23
    s_mov_b32 s34, 1835008
    s_mov_b32 s35, 0x20000
    s_and_b32 s55, s30, 1
    s_add_u32 s40, s28, 2097152
    s_addc_u32 s41, s29, 0
    s_mov_b32 s42, 4194304
    s_mov_b32 s43, 0x20000
    s_add_u32 s44, s28, 65536
    s_addc_u32 s45, s29, 0
    s_mov_b32 s46, 32768
    s_mov_b32 s47, 0x20000
    v_lshrrev_b32 v62, 3, v1
    v_lshlrev_b32 v62, 17, v62
    v_and_b32 v63, 7, v1
    v_lshl_add_u32 v62, v63, 4, v62
    s_lshr_b32 s63, s30, 1
    s_lshl_b32 s63, s63, 15
    s_lshl_b32 s57, s55, 7
    s_add_u32 s63, s63, s57
    s_lshl_b32 s57, s31, 8
    s_add_u32 s63, s63, s57
    s_waitcnt lgkmcnt(0)
    s_add_u32 s3, s3, 1
    s_add_u32 s96, s3, 0
    s_and_b32 s96, s96, 0xff
    s_add_u32 s97, s3, 53
    s_and_b32 s97, s97, 0xff
    s_add_u32 s98, s3, 106
    s_and_b32 s98, s98, 0xff
    s_add_u32 s99, s3, 159
    s_and_b32 s99, s99, 0xff
    v_and_b32 v8, 3, v2
    v_lshlrev_b32 v8, 2, v8
    v_lshrrev_b32 v9, 2, v2
    v_sub_u32 v9, 0, v9
    v_and_b32 v9, 3, v9
    v_or_b32 v8, v8, v9
    v_xor_b32 v8, v8, v3
    v_lshlrev_b32 v8, 4, v8
    v_lshl_add_u32 v10, v2, 9, v8
    s_lshl_b32 s56, s30, 13
    v_add_u32 v10, s56, v10
    v_xor_b32 v16, 0, v10
    v_add_u32 v20, 65536, v16
    v_xor_b32 v17, 64, v10
    v_add_u32 v21, 65536, v17
    v_xor_b32 v18, 128, v10
    v_add_u32 v22, 65536, v18
    v_xor_b32 v19, 192, v10
    v_add_u32 v23, 65536, v19
    v_xor_b32 v9, v3, v2
    v_lshlrev_b32 v9, 4, v9
    v_lshl_add_u32 v9, v2, 10, v9
    v_add_u32 v9, 131072, v9
    v_xor_b32 v24, 0, v9
    v_xor_b32 v25, 64, v9
    v_xor_b32 v26, 128, v9
    v_xor_b32 v27, 192, v9
    v_bfe_u32 v11, v1, 2, 2
    v_lshl_add_u32 v12, v7, 2, v11
    v_lshlrev_b32 v12, 9, v12
    v_and_b32 v13, 1, v1
    v_lshl_add_u32 v12, v13, 3, v12
    s_lshr_b32 s56, s30, 2
    s_lshl_b32 s56, s56, 16
    s_bfe_u32 s57, s30, 0x10001
    s_lshl_b32 s57, s57, 8
    s_add_u32 s56, s56, s57
    v_add_u32 v12, s56, v12
    v_bfe_u32 v13, v1, 4, 1
    v_bfe_u32 v14, v1, 1, 1
    v_lshl_add_u32 v13, v13, 1, v14
    v_mul_u32_u24 v14, 3, v7
    v_xor_b32 v13, v13, v14
    s_lshl_b32 s56, s55, 1
    v_xor_b32 v14, s56, v11
    v_lshl_add_u32 v13, v14, 2, v13
    v_lshl_add_u32 v32, v13, 4, v12
    v_xor_b32 v33, 32, v32
    v_add_u32 v33, 4096, v33
    v_xor_b32 v34, 64, v32
    v_xor_b32 v35, 64, v33
    v_lshlrev_b32 v13, 5, v6
    s_lshl_b32 s56, s30, 2
    v_add_u32 v14, s56, v13
    v_and_b32 v15, 1, v3
    v_lshlrev_b32 v15, 9, v15
    v_lshl_add_u32 v15, v2, 4, v15
    v_lshrrev_b32 v11, 1, v3
    v_lshl_add_u32 v15, v11, 3, v15
    s_lshl_b32 s56, s30, 10
    v_add_u32 v15, s56, v15
    v_and_b32 v11, 16, v1
    s_lshl_b32 s54, s52, 15
    s_add_u32 s36, s28, s54
    s_addc_u32 s37, s29, 0
    s_mov_b32 s38, 32768
    s_mov_b32 s39, 0x20000
    s_lshl_b32 s62, s30, 12
    s_and_b32 s56, s30, 3
    s_lshl_b32 s56, s56, 6
    v_xor_b32 v53, s56, v4
    s_add_u32 s59, s62, 131072
    v_add_u32 v53, s59, v53
    v_lshlrev_b32 v36, 2, v2
    s_mov_b32 s60, 0x7f4a7c15
    s_mov_b32 s61, 0x9e3779b9
    v_lshrrev_b64 v[38:39], v36, s[60:61]
    v_xor_b32 v36, s3, v38
    v_bfe_u32 v56, v36, 0, 1
    v_bfe_u32 v57, v36, 1, 1
    v_bfe_u32 v58, v36, 2, 1
    v_bfe_u32 v59, v36, 3, 1
    s_waitcnt vmcnt(0) lgkmcnt(0)
    s_barrier
    buffer_load_dwordx4 v[36:39], v4, s[36:39], s62 offen offset:0 sc1
    buffer_load_dwordx4 v[40:43], v4, s[36:39], s62 offen offset:1024 sc1
    buffer_load_dwordx4 v[44:47], v4, s[36:39], s62 offen offset:2048 sc1
    buffer_load_dwordx4 v[48:51], v4, s[36:39], s62 offen offset:3072 sc1
    ds_read_b128 v[64:67], v16 offset:0
    ds_read_b128 v[68:71], v17 offset:0
    ds_read_b128 v[72:75], v18 offset:0
    ds_read_b128 v[76:79], v19 offset:0
    ds_read_b128 v[80:83], v16 offset:256
    ds_read_b128 v[84:87], v17 offset:256
    ds_read_b128 v[88:91], v18 offset:256
    ds_read_b128 v[92:95], v19 offset:256
    ds_read_b128 v[96:99], v20 offset:0
    ds_read_b128 v[100:103], v21 offset:0
    ds_read_b128 v[104:107], v22 offset:0
    ds_read_b128 v[108:111], v23 offset:0
    ds_read_b128 v[112:115], v20 offset:256
    ds_read_b128 v[116:119], v21 offset:256
    ds_read_b128 v[120:123], v22 offset:256
    ds_read_b128 v[124:127], v23 offset:256
    v_mov_b32 v16, v212
    ds_read_b64_tr_b16 v[128:129], v32 offset:0
    ds_read_b64_tr_b16 v[130:131], v33 offset:0
    ds_read_b64_tr_b16 v[132:133], v34 offset:0
    ds_read_b64_tr_b16 v[134:135], v35 offset:0
    ds_read_b64_tr_b16 v[136:137], v32 offset:8192
    ds_read_b64_tr_b16 v[138:139], v33 offset:8192
    ds_read_b64_tr_b16 v[140:141], v34 offset:8192
    ds_read_b64_tr_b16 v[142:143], v35 offset:8192
    ds_read_b64_tr_b16 v[144:145], v32 offset:16384
    ds_read_b64_tr_b16 v[146:147], v33 offset:16384
    ds_read_b64_tr_b16 v[148:149], v34 offset:16384
    ds_read_b64_tr_b16 v[150:151], v35 offset:16384
    ds_read_b64_tr_b16 v[152:153], v32 offset:24576
    ds_read_b64_tr_b16 v[154:155], v33 offset:24576
    ds_read_b64_tr_b16 v[156:157], v34 offset:24576
    ds_read_b64_tr_b16 v[158:159], v35 offset:24576
    ds_read_b64_tr_b16 v[160:161], v32 offset:32768
    ds_read_b64_tr_b16 v[162:163], v33 offset:32768
    ds_read_b64_tr_b16 v[164:165], v34 offset:32768
    ds_read_b64_tr_b16 v[166:167], v35 offset:32768
    ds_read_b64_tr_b16 v[168:169], v32 offset:40960
    ds_read_b64_tr_b16 v[170:171], v33 offset:40960
    ds_read_b64_tr_b16 v[172:173], v34 offset:40960
    ds_read_b64_tr_b16 v[174:175], v35 offset:40960
    ds_read_b64_tr_b16 v[176:177], v32 offset:49152
    ds_read_b64_tr_b16 v[178:179], v33 offset:49152
    ds_read_b64_tr_b16 v[180:181], v34 offset:49152
    ds_read_b64_tr_b16 v[182:183], v35 offset:49152
    ds_read_b64_tr_b16 v[184:185], v32 offset:57344
    ds_read_b64_tr_b16 v[186:187], v33 offset:57344
    ds_read_b64_tr_b16 v[188:189], v34 offset:57344
    ds_read_b64_tr_b16 v[190:191], v35 offset:57344
    s_mov_b32 s100, 20000
    s_waitcnt vmcnt(0)
Lqa6:
    v_xor_b32 v52, v56, v36
    v_xor_b32 v54, v57, v37
    v_xor_b32 v55, v58, v38
    v_or3_b32 v52, v52, v54, v55
    v_xor_b32 v54, v59, v39
    v_xor_b32 v55, v56, v40
    v_or3_b32 v52, v52, v54, v55
    v_xor_b32 v54, v57, v41
    v_xor_b32 v55, v58, v42
    v_or3_b32 v52, v52, v54, v55
    v_xor_b32 v54, v59, v43
    v_xor_b32 v55, v56, v44
    v_or3_b32 v52, v52, v54, v55
    v_xor_b32 v54, v57, v45
    v_xor_b32 v55, v58, v46
    v_or3_b32 v52, v52, v54, v55
    v_xor_b32 v54, v59, v47
    v_xor_b32 v55, v56, v48
    v_or3_b32 v52, v52, v54, v55
    v_xor_b32 v54, v57, v49
    v_xor_b32 v55, v58, v50
    v_or3_b32 v52, v52, v54, v55
    v_xor_b32 v54, v59, v51
    v_or_b32 v52, v52, v54
    v_and_b32 v52, 1, v52
    v_cmp_ne_u32 vcc, 0, v52
    s_nop 1
    s_cmp_eq_u64 vcc, 0
    s_cbranch_scc1 Lqad6
    s_sub_u32 s100, s100, 1
    s_cmp_eq_u32 s100, 0
    s_cbranch_scc1 Lqad6
    buffer_load_dwordx4 v[36:39], v4, s[36:39], s62 offen offset:0 sc1
    buffer_load_dwordx4 v[40:43], v4, s[36:39], s62 offen offset:1024 sc1
    buffer_load_dwordx4 v[44:47], v4, s[36:39], s62 offen offset:2048 sc1
    buffer_load_dwordx4 v[48:51], v4, s[36:39], s62 offen offset:3072 sc1
    s_waitcnt vmcnt(0)
    s_branch Lqa6
Lqad6:
    v_xor_b32 v54, 0, v53
    ds_write_b128 v54, v[36:39] offset:0
    v_xor_b32 v54, 16, v53
    ds_write_b128 v54, v[40:43] offset:1024
    v_xor_b32 v54, 32, v53
    ds_write_b128 v54, v[44:47] offset:2048
    v_xor_b32 v54, 48, v53
    ds_write_b128 v54, v[48:51] offset:3072
    s_waitcnt vmcnt(0) lgkmcnt(0)
    s_barrier
    ds_read_b128 v[192:195], v24 offset:0
    ds_read_b128 v[196:199], v24 offset:16384
    ds_read_b128 v[200:203], v25 offset:0
    ds_read_b128 v[204:207], v25 offset:16384
    ds_read_b128 v[208:211], v26 offset:0
    ds_read_b128 v[212:215], v26 offset:16384
    ds_read_b128 v[216:219], v27 offset:0
    ds_read_b128 v[220:223], v27 offset:16384
    s_waitcnt lgkmcnt(7)
    v_mfma_f32_16x16x32_bf16 v[36:39], v[64:67], v[192:195], 0
    ds_read_b128 v[192:195], v24 offset:256
    s_waitcnt lgkmcnt(7)
    v_mfma_f32_16x16x32_bf16 v[40:43], v[64:67], v[196:199], 0
    ds_read_b128 v[196:199], v24 offset:16640
    s_waitcnt lgkmcnt(7)
    v_mfma_f32_16x16x32_bf16 v[36:39], v[68:71], v[200:203], v[36:39]
    ds_read_b128 v[200:203], v25 offset:256
    s_waitcnt lgkmcnt(7)
    v_mfma_f32_16x16x32_bf16 v[40:43], v[68:71], v[204:207], v[40:43]
    ds_read_b128 v[204:207], v25 offset:16640
    s_waitcnt lgkmcnt(7)
    v_mfma_f32_16x16x32_bf16 v[36:39], v[72:75], v[208:211], v[36:39]
    ds_read_b128 v[208:211], v26 offset:256
    s_waitcnt lgkmcnt(7)
    v_mfma_f32_16x16x32_bf16 v[40:43], v[72:75], v[212:215], v[40:43]
    ds_read_b128 v[212:215], v26 offset:16640
    s_waitcnt lgkmcnt(7)
    v_mfma_f32_16x16x32_bf16 v[36:39], v[76:79], v[216:219], v[36:39]
    ds_read_b128 v[216:219], v27 offset:256
    s_waitcnt lgkmcnt(7)
    v_mfma_f32_16x16x32_bf16 v[40:43], v[76:79], v[220:223], v[40:43]
    ds_read_b128 v[220:223], v27 offset:16640
    s_waitcnt lgkmcnt(7)
    v_mfma_f32_16x16x32_bf16 v[36:39], v[80:83], v[192:195], v[36:39]
    ds_read_b128 v[192:195], v24 offset:512
    s_waitcnt lgkmcnt(7)
    v_mfma_f32_16x16x32_bf16 v[40:43], v[80:83], v[196:199], v[40:43]
    ds_read_b128 v[196:199], v24 offset:16896
    s_waitcnt lgkmcnt(7)
    v_mfma_f32_16x16x32_bf16 v[36:39], v[84:87], v[200:203], v[36:39]
    ds_read_b128 v[200:203], v25 offset:512
    s_waitcnt lgkmcnt(7)
    v_mfma_f32_16x16x32_bf16 v[40:43], v[84:87], v[204:207], v[40:43]
    ds_read_b128 v[204:207], v25 offset:16896
    s_waitcnt lgkmcnt(7)
    v_mfma_f32_16x16x32_bf16 v[36:39], v[88:91], v[208:211], v[36:39]
    ds_read_b128 v[208:211], v26 offset:512
    s_waitcnt lgkmcnt(7)
    v_mfma_f32_16x16x32_bf16 v[40:43], v[88:91], v[212:215], v[40:43]
    ds_read_b128 v[212:215], v26 offset:16896
    s_waitcnt lgkmcnt(7)
    v_mfma_f32_16x16x32_bf16 v[36:39], v[92:95], v[216:219], v[36:39]
    ds_read_b128 v[216:219], v27 offset:512
    s_waitcnt lgkmcnt(7)
    v_mfma_f32_16x16x32_bf16 v[40:43], v[92:95], v[220:223], v[40:43]
    ds_read_b128 v[220:223], v27 offset:16896
    s_waitcnt lgkmcnt(7)
    v_mfma_f32_16x16x32_bf16 v[36:39], v[96:99], v[192:195], v[36:39]
    ds_read_b128 v[192:195], v24 offset:768
    s_waitcnt lgkmcnt(7)
    v_mfma_f32_16x16x32_bf16 v[40:43], v[96:99], v[196:199], v[40:43]
    ds_read_b128 v[196:199], v24 offset:17152
    s_waitcnt lgkmcnt(7)
    v_mfma_f32_16x16x32_bf16 v[36:39], v[100:103], v[200:203], v[36:39]
    ds_read_b128 v[200:203], v25 offset:768
    s_waitcnt lgkmcnt(7)
    v_mfma_f32_16x16x32_bf16 v[40:43], v[100:103], v[204:207], v[40:43]
    ds_read_b128 v[204:207], v25 offset:17152
    s_waitcnt lgkmcnt(7)
    v_mfma_f32_16x16x32_bf16 v[36:39], v[104:107], v[208:211], v[36:39]
    ds_read_b128 v[208:211], v26 offset:768
    s_waitcnt lgkmcnt(7)
    v_mfma_f32_16x16x32_bf16 v[40:43], v[104:107], v[212:215], v[40:43]
    ds_read_b128 v[212:215], v26 offset:17152
    s_waitcnt lgkmcnt(7)
    v_mfma_f32_16x16x32_bf16 v[36:39], v[108:111], v[216:219], v[36:39]
    ds_read_b128 v[216:219], v27 offset:768
    s_waitcnt lgkmcnt(7)
    v_mfma_f32_16x16x32_bf16 v[40:43], v[108:111], v[220:223], v[40:43]
    ds_read_b128 v[220:223], v27 offset:17152
    s_waitcnt lgkmcnt(7)
    v_mfma_f32_16x16x32_bf16 v[36:39], v[112:115], v[192:195], v[36:39]
    buffer_load_dwordx4 v[224:227], v16, s[32:35], s53 offen offset:0 nt
    s_waitcnt lgkmcnt(6)
    v_mfma_f32_16x16x32_bf16 v[40:43], v[112:115], v[196:199], v[40:43]
    buffer_load_dwordx4 v[228:231], v16, s[32:35], s53 offen offset:1024 nt
    s_waitcnt lgkmcnt(5)
    v_mfma_f32_16x16x32_bf16 v[36:39], v[116:119], v[200:203], v[36:39]
    s_waitcnt lgkmcnt(4)
    v_mfma_f32_16x16x32_bf16 v[40:43], v[116:119], v[204:207], v[40:43]
    s_waitcnt lgkmcnt(3)
    v_mfma_f32_16x16x32_bf16 v[36:39], v[120:123], v[208:211], v[36:39]
    s_waitcnt lgkmcnt(2)
    v_mfma_f32_16x16x32_bf16 v[40:43], v[120:123], v[212:215], v[40:43]
    s_waitcnt lgkmcnt(1)
    v_mfma_f32_16x16x32_bf16 v[36:39], v[124:127], v[216:219], v[36:39]
    s_waitcnt lgkmcnt(0)
    v_mfma_f32_16x16x32_bf16 v[40:43], v[124:127], v[220:223], v[40:43]
    s_nop 5
    v_max3_f32 v52, v36, v37, v38
    s_nop 0
    v_max3_f32 v53, v40, v41, v42
    v_max_f32 v52, v52, v39
    v_max_f32 v53, v53, v43
    v_cmp_ne_u32 vcc, 0, v11
    v_mov_b32 v54, v52
    v_mov_b32 v55, v53
    s_nop 0
    v_permlane16_swap_b32 v52, v54
    v_permlane16_swap_b32 v53, v55
    v_max_f32 v52, v52, v54
    v_max_f32 v53, v53, v55
    v_mov_b32 v54, v52
    v_mov_b32 v55, v53
    s_nop 0
    v_permlane32_swap_b32 v52, v54
    v_permlane32_swap_b32 v53, v55
    v_max_f32 v52, v52, v54
    v_max_f32 v53, v53, v55
    v_cndmask_b32 v52, v52, v53, vcc
    ds_write_b32 v14, v52 offset:24576
    s_waitcnt lgkmcnt(0)
    s_barrier
    ds_read_b128 v[52:55], v13 offset:24576
    ds_read_b128 v[56:59], v13 offset:24592
    s_waitcnt lgkmcnt(0)
    v_max3_f32 v52, v52, v53, v54
    v_max3_f32 v56, v56, v57, v58
    v_max3_f32 v52, v52, v55, v59
    v_max_f32 v60, v52, v56
    v_mov_b32 v52, v60
    v_mov_b32 v53, v60
    s_nop 1
    v_permlane16_swap_b32 v52, v53
    v_sub_f32 v36, v36, v52
    v_sub_f32 v37, v37, v52
    v_sub_f32 v38, v38, v52
    v_sub_f32 v39, v39, v52
    v_sub_f32 v40, v40, v53
    v_sub_f32 v41, v41, v53
    v_sub_f32 v42, v42, v53
    v_sub_f32 v43, v43, v53
    v_exp_f32 v36, v36
    v_exp_f32 v37, v37
    v_exp_f32 v38, v38
    v_exp_f32 v39, v39
    v_exp_f32 v40, v40
    v_exp_f32 v41, v41
    v_exp_f32 v42, v42
    v_exp_f32 v43, v43
    v_cvt_pk_bf16_f32 v52, v36, v37
    v_cvt_pk_bf16_f32 v53, v38, v39
    v_cvt_pk_bf16_f32 v54, v40, v41
    v_cvt_pk_bf16_f32 v55, v42, v43
    ds_write_b64 v15, v[52:53] offset:16384
    ds_write_b64 v15, v[54:55] offset:16640
    v_add_f32 v44, v36, v37
    v_add_f32 v45, v38, v39
    v_add_f32 v46, v40, v41
    v_add_f32 v47, v42, v43
    v_add_f32 v44, v44, v45
    v_add_f32 v45, v46, v47
    v_mov_b32 v46, v44
    v_mov_b32 v47, v45
    s_nop 0
    v_permlane16_swap_b32 v44, v46
    v_permlane16_swap_b32 v45, v47
    v_add_f32 v44, v44, v46
    v_add_f32 v45, v45, v47
    v_mov_b32 v46, v44
    v_mov_b32 v47, v45
    s_nop 0
    v_permlane32_swap_b32 v44, v46
    v_permlane32_swap_b32 v45, v47
    v_add_f32 v44, v44, v46
    v_add_f32 v45, v45, v47
    v_cndmask_b32 v44, v44, v45, vcc
    ds_write_b32 v14, v44 offset:25600
    s_waitcnt lgkmcnt(0)
    s_barrier
    s_cmp_lg_u32 s30, 0
    s_cbranch_scc1 Latt_ns7
    ds_read_b128 v[36:39], v13 offset:25600
    ds_read_b128 v[40:43], v13 offset:25616
    v_mov_b32 v17, 0xffffff00
    v_lshlrev_b32 v19, 3, v6
    s_lshl_b32 s57, s31, 8
    s_waitcnt lgkmcnt(0)
    v_pk_add_f32 v[36:37], v[36:37], v[38:39]
    v_pk_add_f32 v[40:41], v[40:41], v[42:43]
    v_pk_add_f32 v[36:37], v[36:37], v[40:41]
    v_add_f32 v61, v36, v37
    v_and_or_b32 v60, v60, v17, s96
    v_and_or_b32 v61, v61, v17, s97
    v_mov_b32 v5, v19
    s_lshl_b32 s57, s31, 8
    s_mov_b32 exec_hi, 0
    buffer_store_dwordx2 v[60:61], v5, s[44:47], s57 offen sc1
    s_mov_b64 exec, -1
Latt_ns7:
    ds_read_b128 v[192:195], v4 offset:16384
    ds_read_b128 v[196:199], v4 offset:17408
    ds_read_b128 v[200:203], v4 offset:18432
    ds_read_b128 v[204:207], v4 offset:19456
    ds_read_b128 v[208:211], v4 offset:20480
    ds_read_b128 v[212:215], v4 offset:21504
    ds_read_b128 v[216:219], v4 offset:22528
    ds_read_b128 v[220:223], v4 offset:23552
    s_waitcnt lgkmcnt(7)
    v_mfma_f32_32x32x16_bf16 v[64:79], v[128:131], v[192:195], 0
    v_mfma_f32_32x32x16_bf16 v[80:95], v[132:135], v[192:195], 0
    s_waitcnt lgkmcnt(6)
    v_mfma_f32_32x32x16_bf16 v[64:79], v[136:139], v[196:199], v[64:79]
    v_mfma_f32_32x32x16_bf16 v[80:95], v[140:143], v[196:199], v[80:95]
    s_waitcnt lgkmcnt(5)
    v_mfma_f32_32x32x16_bf16 v[64:79], v[144:147], v[200:203], v[64:79]
    v_mfma_f32_32x32x16_bf16 v[80:95], v[148:151], v[200:203], v[80:95]
    s_waitcnt lgkmcnt(4)
    v_mfma_f32_32x32x16_bf16 v[64:79], v[152:155], v[204:207], v[64:79]
    v_mfma_f32_32x32x16_bf16 v[80:95], v[156:159], v[204:207], v[80:95]
    s_waitcnt lgkmcnt(3)
    v_mfma_f32_32x32x16_bf16 v[64:79], v[160:163], v[208:211], v[64:79]
    v_mfma_f32_32x32x16_bf16 v[80:95], v[164:167], v[208:211], v[80:95]
    s_waitcnt lgkmcnt(2)
    v_mfma_f32_32x32x16_bf16 v[64:79], v[168:171], v[212:215], v[64:79]
    v_mfma_f32_32x32x16_bf16 v[80:95], v[172:175], v[212:215], v[80:95]
    s_waitcnt lgkmcnt(1)
    v_mfma_f32_32x32x16_bf16 v[64:79], v[176:179], v[216:219], v[64:79]
    v_mfma_f32_32x32x16_bf16 v[80:95], v[180:183], v[216:219], v[80:95]
    s_waitcnt lgkmcnt(0)
    v_mfma_f32_32x32x16_bf16 v[64:79], v[184:187], v[220:223], v[64:79]
    v_mfma_f32_32x32x16_bf16 v[80:95], v[188:191], v[220:223], v[80:95]
    v_and_b32 v116, 7, v1
    s_lshl_b32 s57, s55, 3
    v_add_u32 v116, s57, v116
    v_lshlrev_b32 v120, 2, v116
    s_mov_b32 s60, 0x7f4a7c15
    s_mov_b32 s61, 0x9e3779b9
    v_lshrrev_b64 v[122:123], v120, s[60:61]
    v_xor_b32 v120, s3, v122
    v_bfe_u32 v112, v120, 0, 1
    v_bfe_u32 v113, v120, 1, 1
    v_bfe_u32 v114, v120, 2, 1
    v_bfe_u32 v115, v120, 3, 1
    s_mul_i32 s56, s30, 4608
    s_add_u32 s56, s56, 32768
    v_mul_u32_u24 v16, 144, v6
    v_lshl_add_u32 v16, v7, 3, v16
    v_add_u32 v16, s56, v16
    v_lshrrev_b32 v17, 3, v1
    v_mul_u32_u24 v18, 144, v17
    v_and_b32 v19, 7, v1
    v_lshl_add_u32 v18, v19, 4, v18
    v_add_u32 v18, s56, v18
    s_lshl_b32 s57, s31, 8
    v_cvt_pk_bf16_f32 v64, v64, v65
    v_cvt_pk_bf16_f32 v65, v66, v67
    ds_write_b64 v16, v[64:65] offset:0
    v_cvt_pk_bf16_f32 v68, v68, v69
    v_cvt_pk_bf16_f32 v69, v70, v71
    ds_write_b64 v16, v[68:69] offset:16
    v_cvt_pk_bf16_f32 v72, v72, v73
    v_cvt_pk_bf16_f32 v73, v74, v75
    ds_write_b64 v16, v[72:73] offset:32
    v_cvt_pk_bf16_f32 v76, v76, v77
    v_cvt_pk_bf16_f32 v77, v78, v79
    ds_write_b64 v16, v[76:77] offset:48
    v_cvt_pk_bf16_f32 v80, v80, v81
    v_cvt_pk_bf16_f32 v81, v82, v83
    ds_write_b64 v16, v[80:81] offset:64
    v_cvt_pk_bf16_f32 v84, v84, v85
    v_cvt_pk_bf16_f32 v85, v86, v87
    ds_write_b64 v16, v[84:85] offset:80
    v_cvt_pk_bf16_f32 v88, v88, v89
    v_cvt_pk_bf16_f32 v89, v90, v91
    ds_write_b64 v16, v[88:89] offset:96
    v_cvt_pk_bf16_f32 v92, v92, v93
    v_cvt_pk_bf16_f32 v93, v94, v95
    ds_write_b64 v16, v[92:93] offset:112
    s_waitcnt lgkmcnt(0)
    ds_read_b128 v[96:99], v18 offset:0
    ds_read_b128 v[100:103], v18 offset:1152
    ds_read_b128 v[104:107], v18 offset:2304
    ds_read_b128 v[108:111], v18 offset:3456
    v_mov_b32 v17, 0xfffffffe
    s_waitcnt lgkmcnt(3)
    v_and_or_b32 v96, v96, v17, v112
    v_and_or_b32 v97, v97, v17, v113
    v_and_or_b32 v98, v98, v17, v114
    v_and_or_b32 v99, v99, v17, v115
    buffer_store_dwordx4 v[96:99], v62, s[40:43], s63 offen sc1
    s_add_u32 s63, s63, 1048576
    s_waitcnt lgkmcnt(2)
    v_and_or_b32 v100, v100, v17, v112
    v_and_or_b32 v101, v101, v17, v113
    v_and_or_b32 v102, v102, v17, v114
    v_and_or_b32 v103, v103, v17, v115
    buffer_store_dwordx4 v[100:103], v62, s[40:43], s63 offen sc1
    s_add_u32 s63, s63, 1048576
    s_waitcnt lgkmcnt(1)
    v_and_or_b32 v104, v104, v17, v112
    v_and_or_b32 v105, v105, v17, v113
    v_and_or_b32 v106, v106, v17, v114
    v_and_or_b32 v107, v107, v17, v115
    buffer_store_dwordx4 v[104:107], v62, s[40:43], s63 offen sc1
    s_add_u32 s63, s63, 1048576
    s_waitcnt lgkmcnt(0)
    v_and_or_b32 v108, v108, v17, v112
    v_and_or_b32 v109, v109, v17, v113
    v_and_or_b32 v110, v110, v17, v114
    v_and_or_b32 v111, v111, v17, v115
    buffer_store_dwordx4 v[108:111], v62, s[40:43], s63 offen sc1
    s_cmp_ge_u32 s31, 112
    s_cbranch_scc1 Ldn_done8
    s_and_b32 s62, s30, 3
    s_lshr_b32 s63, s30, 2
    v_and_b32 v28, 1, v1
    v_cmp_eq_u32 vcc, 1, v28
    v_mov_b32 v28, 0xffff
    v_mov_b32 v29, 0xffff0000
    v_cndmask_b32 v28, v28, v29, vcc
    v_bfe_u32 v29, v1, 1, 2
    v_cmp_eq_u32 vcc, 0, v29
    s_nop 1
    v_cndmask_b32 v24, 0, v28, vcc
    v_cmp_eq_u32 vcc, 1, v29
    s_nop 1
    v_cndmask_b32 v25, 0, v28, vcc
    v_cmp_eq_u32 vcc, 2, v29
    s_nop 1
    v_cndmask_b32 v26, 0, v28, vcc
    v_cmp_eq_u32 vcc, 3, v29
    s_nop 1
    v_cndmask_b32 v27, 0, v28, vcc
    v_bfe_u32 v5, v1, 3, 1
    v_mul_u32_u24 v5, 14336, v5
    v_lshl_add_u32 v5, v3, 3, v5
    s_lshl_b32 s54, s31, 4
    s_lshl_b32 s55, s63, 3
    s_add_u32 s54, s54, s55
    s_lshl_b32 s54, s54, 2
    s_add_u32 s32, s28, 786432
    s_addc_u32 s33, s29, 0
    s_mov_b32 s34, 114688
    s_mov_b32 s35, 0x20000
    v_and_b32 v14, 1, v3
    v_cmp_eq_u32 vcc, 1, v14
    v_mov_b32 v14, s96
    v_mov_b32 v15, s98
    v_cndmask_b32 v14, v14, v15, vcc
    v_mov_b32 v15, s97
    v_mov_b32 v13, s99
    v_cndmask_b32 v15, v15, v13, vcc
    s_mov_b32 s100, 20000
Lspin9:
    s_mov_b32 s55, s54
    buffer_load_dwordx2 v[128:129], v5, s[32:35], s55 offen sc1
    s_add_u32 s55, s55, 7168
    buffer_load_dwordx2 v[130:131], v5, s[32:35], s55 offen sc1
    s_add_u32 s55, s55, 21504
    buffer_load_dwordx2 v[132:133], v5, s[32:35], s55 offen sc1
    s_add_u32 s55, s55, 7168
    buffer_load_dwordx2 v[134:135], v5, s[32:35], s55 offen sc1
    s_add_u32 s55, s55, 21504
    buffer_load_dwordx2 v[136:137], v5, s[32:35], s55 offen sc1
    s_add_u32 s55, s55, 7168
    buffer_load_dwordx2 v[138:139], v5, s[32:35], s55 offen sc1
    s_add_u32 s55, s55, 21504
    buffer_load_dwordx2 v[140:141], v5, s[32:35], s55 offen sc1
    s_add_u32 s55, s55, 7168
    buffer_load_dwordx2 v[142:143], v5, s[32:35], s55 offen sc1
    s_waitcnt vmcnt(0)
    v_xor_b32 v10, v14, v128
    v_xor_b32 v11, v15, v129
    v_xor_b32 v12, v14, v130
    v_or3_b32 v10, v10, v11, v12
    v_xor_b32 v11, v15, v131
    v_xor_b32 v12, v14, v132
    v_or3_b32 v10, v10, v11, v12
    v_xor_b32 v11, v15, v133
    v_xor_b32 v12, v14, v134
    v_or3_b32 v10, v10, v11, v12
    v_xor_b32 v11, v15, v135
    v_xor_b32 v12, v14, v136
    v_or3_b32 v10, v10, v11, v12
    v_xor_b32 v11, v15, v137
    v_xor_b32 v12, v14, v138
    v_or3_b32 v10, v10, v11, v12
    v_xor_b32 v11, v15, v139
    v_xor_b32 v12, v14, v140
    v_or3_b32 v10, v10, v11, v12
    v_xor_b32 v11, v15, v141
    v_xor_b32 v12, v14, v142
    v_or3_b32 v10, v10, v11, v12
    v_xor_b32 v11, v15, v143
    v_or_b32 v10, v10, v11
    v_and_b32 v10, 0xff, v10
    v_cmp_ne_u32 vcc, 0, v10
    s_nop 1
    s_cmp_eq_u64 vcc, 0
    s_cbranch_scc1 Lspind9
    s_sub_u32 s100, s100, 1
    s_cmp_lg_u32 s100, 0
    s_cbranch_scc1 Lspin9
Lspind9:
    s_nop 0
    v_add_f32 v128, v128, v132
    v_add_f32 v136, v136, v140
    v_add_f32 v129, v129, v133
    v_add_f32 v137, v137, v141
    v_add_f32 v130, v130, v134
    v_add_f32 v138, v138, v142
    v_add_f32 v131, v131, v135
    v_add_f32 v139, v139, v143
    v_add_f32 v128, v128, v136
    v_add_f32 v129, v129, v137
    v_add_f32 v130, v130, v138
    v_add_f32 v131, v131, v139
    v_max_f32 v32, 0, v128
    v_mul_f32 v32, v32, v130
    v_cvt_pk_bf16_f32 v32, v32, v32
    v_max_f32 v33, 0, v129
    v_mul_f32 v33, v33, v131
    v_cvt_pk_bf16_f32 v33, v33, v33
    v_and_b32 v96, v32, v24
    v_and_b32 v97, v32, v25
    v_and_b32 v98, v32, v26
    v_and_b32 v99, v32, v27
    v_and_b32 v100, v33, v24
    v_and_b32 v101, v33, v25
    v_and_b32 v102, v33, v26
    v_and_b32 v103, v33, v27
    v_mfma_f32_16x16x32_bf16 v[52:55], v[96:99], v[224:227], 0
    s_nop 0
    v_mfma_f32_16x16x32_bf16 v[52:55], v[100:103], v[228:231], v[52:55]
    s_lshl_b32 s59, s30, 10
    v_add_u32 v8, s59, v4
    v_add_u32 v8, 81920, v8
    s_nop 4
    ds_write_b128 v8, v[52:55]
    s_waitcnt lgkmcnt(0)
    s_barrier
    s_cmp_ge_u32 s30, 4
    s_cbranch_scc1 Ldn_done8
    ds_read_b128 v[64:67], v8 offset:0
    ds_read_b128 v[68:71], v8 offset:4096
    s_waitcnt lgkmcnt(0)
    v_pk_add_f32 v[52:53], v[64:65], v[68:69]
    v_pk_add_f32 v[54:55], v[66:67], v[70:71]
    s_add_u32 s48, s28, 1572864
    s_addc_u32 s49, s29, 0
    s_mov_b32 s50, 458752
    s_mov_b32 s51, 0x20000
    v_lshrrev_b32 v9, 5, v1
    v_mul_u32_u24 v9, 229376, v9
    v_lshrrev_b32 v10, 2, v2
    v_mul_u32_u24 v10, 14336, v10
    v_add_u32 v9, v9, v10
    v_and_b32 v10, 3, v2
    v_lshl_add_u32 v9, v10, 5, v9
    v_and_b32 v10, 1, v3
    v_lshl_add_u32 v9, v10, 4, v9
    s_lshl_b32 s59, s31, 7
    s_mul_i32 s57, s62, 57344
    s_add_u32 s59, s59, s57
    v_mov_b32 v10, 0xffffff00
    v_and_or_b32 v52, v52, v10, s96
    v_and_or_b32 v53, v53, v10, s97
    v_and_or_b32 v54, v54, v10, s98
    v_and_or_b32 v55, v55, v10, s99
    buffer_store_dwordx4 v[52:55], v9, s[48:51], s59 offen sc1
Ldn_done8:
    s_cmp_lt_u32 s31, 96
    s_cbranch_scc1 Latt_end
    s_sub_u32 s50, s31, 96
    s_mul_i32 s53, s50, 14336
    s_mul_i32 s54, s30, 1792
    s_add_u32 s53, s53, s54
    s_lshl_b32 s56, s50, 14
    s_lshl_b32 s57, s30, 11
    s_add_u32 s56, s56, s57
    s_add_u32 s32, s28, 262144
    s_addc_u32 s33, s29, 0
    s_mov_b32 s34, 524288
    s_mov_b32 s35, 0x20000
    s_add_u32 s36, s28, 1572864
    s_addc_u32 s37, s29, 0
    s_mov_b32 s38, 458752
    s_mov_b32 s39, 0x20000
    s_mov_b32 s40, s4
    s_mov_b32 s41, s5
    s_mov_b32 s42, 2048
    s_mov_b32 s43, 0x20000
    v_and_b32 v26, 7, v1
    v_lshlrev_b32 v27, 1, v1
    s_lshl_b32 s55, s50, 6
    buffer_load_ushort v24, v27, s[40:43], s55 offen
    s_lshl_b32 s57, s30, 8
    s_add_u32 s57, s57, 73728
    v_lshl_add_u32 v25, v26, 4, s57
    s_mov_b32 s59, 0
    s_branch Lftail10
Lfreal10:
    s_mov_b32 s100, 20000
Lspin11:
    buffer_load_dwordx4 v[16:19], v4, s[36:39], s53 offen sc1
    v_mov_b32 v20, s96
    v_mov_b32 v21, s97
    v_mov_b32 v22, s98
    v_mov_b32 v23, s99
    s_mov_b32 exec_hi, 0xffff
    buffer_load_dwordx4 v[20:23], v4, s[36:39], s53 offen offset:1024 sc1
    s_mov_b64 exec, -1
    buffer_load_dwordx4 v[8:11], v4, s[32:35], s56 offen sc1
    buffer_load_dwordx4 v[12:15], v4, s[32:35], s56 offen offset:1024 sc1
    s_waitcnt vmcnt(0)
    v_xor_b32 v28, s96, v16
    v_xor_b32 v29, s97, v17
    v_xor_b32 v30, s98, v18
    v_or3_b32 v28, v28, v29, v30
    v_xor_b32 v29, s99, v19
    v_xor_b32 v30, s96, v20
    v_or3_b32 v28, v28, v29, v30
    v_xor_b32 v29, s97, v21
    v_xor_b32 v30, s98, v22
    v_or3_b32 v28, v28, v29, v30
    v_xor_b32 v29, s99, v23
    v_or_b32 v28, v28, v29
    v_and_b32 v28, 0xff, v28
    v_cmp_ne_u32 vcc, 0, v28
    s_nop 1
    s_cmp_eq_u64 vcc, 0
    s_cbranch_scc1 Lspind11
    s_sub_u32 s100, s100, 1
    s_cmp_lg_u32 s100, 0
    s_cbranch_scc1 Lspin11
Lspind11:
    s_nop 0
    v_add_f32 v16, v16, v20
    v_add_f32 v17, v17, v21
    v_add_f32 v18, v18, v22
    v_add_f32 v19, v19, v23
    v_add_f32_dpp v16, v16, v16 row_ror:8 row_mask:0xf bank_mask:0xf
    v_add_f32_dpp v17, v17, v17 row_ror:8 row_mask:0xf bank_mask:0xf
    v_add_f32_dpp v18, v18, v18 row_ror:8 row_mask:0xf bank_mask:0xf
    v_add_f32_dpp v19, v19, v19 row_ror:8 row_mask:0xf bank_mask:0xf
    v_mov_b32 v32, v16
    v_mov_b32 v33, v17
    v_mov_b32 v34, v18
    v_mov_b32 v35, v19
    v_permlane16_swap_b32 v16, v32
    v_permlane16_swap_b32 v17, v33
    v_permlane16_swap_b32 v18, v34
    v_permlane16_swap_b32 v19, v35
    v_add_f32 v16, v16, v32
    v_add_f32 v17, v17, v33
    v_add_f32 v18, v18, v34
    v_add_f32 v19, v19, v35
    v_mov_b32 v32, v16
    v_mov_b32 v33, v17
    v_mov_b32 v34, v18
    v_mov_b32 v35, v19
    v_permlane32_swap_b32 v16, v32
    v_permlane32_swap_b32 v17, v33
    v_permlane32_swap_b32 v18, v34
    v_permlane32_swap_b32 v19, v35
    v_add_f32 v16, v16, v32
    v_add_f32 v17, v17, v33
    v_add_f32 v18, v18, v34
    v_add_f32 v19, v19, v35
    s_mov_b64 exec, 0xff
    ds_write_b128 v25, v[16:19] offset:128
    s_mov_b64 exec, -1
    s_mov_b32 s100, 20000
Lfs12:
    v_xor_b32 v28, s96, v8
    v_xor_b32 v29, s97, v9
    v_xor_b32 v30, s98, v10
    v_or3_b32 v28, v28, v29, v30
    v_xor_b32 v29, s99, v11
    v_xor_b32 v30, s96, v12
    v_or3_b32 v28, v28, v29, v30
    v_xor_b32 v29, s97, v13
    v_xor_b32 v30, s98, v14
    v_or3_b32 v28, v28, v29, v30
    v_xor_b32 v29, s99, v15
    v_or_b32 v28, v28, v29
    v_and_b32 v28, 0xff, v28
    v_cmp_ne_u32 vcc, 0, v28
    s_nop 1
    s_cmp_eq_u64 vcc, 0
    s_cbranch_scc1 Lfsd12
    s_sub_u32 s100, s100, 1
    s_cmp_eq_u32 s100, 0
    s_cbranch_scc1 Lfsd12
    buffer_load_dwordx4 v[8:11], v4, s[32:35], s56 offen sc1
    buffer_load_dwordx4 v[12:15], v4, s[32:35], s56 offen offset:1024 sc1
    s_waitcnt vmcnt(0)
    s_branch Lfs12
Lfsd12:
    s_mov_b32 s59, 1
Lftail10:
    v_pk_add_f32 v[8:9], v[8:9], v[12:13]
    v_pk_add_f32 v[10:11], v[10:11], v[14:15]
    s_nop 0
    v_add_f32_dpp v8, v8, v8 row_ror:8 row_mask:0xf bank_mask:0xf
    v_add_f32_dpp v9, v9, v9 row_ror:8 row_mask:0xf bank_mask:0xf
    v_add_f32_dpp v10, v10, v10 row_ror:8 row_mask:0xf bank_mask:0xf
    v_add_f32_dpp v11, v11, v11 row_ror:8 row_mask:0xf bank_mask:0xf
    v_mov_b32 v32, v8
    v_mov_b32 v33, v9
    v_mov_b32 v34, v10
    v_mov_b32 v35, v11
    v_permlane16_swap_b32 v8, v32
    v_permlane16_swap_b32 v9, v33
    v_permlane16_swap_b32 v10, v34
    v_permlane16_swap_b32 v11, v35
    v_add_f32 v8, v8, v32
    v_add_f32 v9, v9, v33
    v_add_f32 v10, v10, v34
    v_add_f32 v11, v11, v35
    v_mov_b32 v32, v8
    v_mov_b32 v33, v9
    v_mov_b32 v34, v10
    v_mov_b32 v35, v11
    v_permlane32_swap_b32 v8, v32
    v_permlane32_swap_b32 v9, v33
    v_permlane32_swap_b32 v10, v34
    v_permlane32_swap_b32 v11, v35
    v_add_f32 v8, v8, v32
    v_add_f32 v9, v9, v33
    v_add_f32 v10, v10, v34
    v_add_f32 v11, v11, v35
    s_mov_b64 exec, 0xff
    ds_write_b128 v25, v[8:11]
    s_mov_b64 exec, -1
    s_waitcnt lgkmcnt(0)
    s_barrier
    s_cmp_lg_u32 s30, 0
    s_cbranch_scc1 Lfin_done13
    v_lshlrev_b32 v23, 2, v1
    v_add_u32 v23, 73728, v23
    ds_read_b32 v8, v23 offset:0
    ds_read_b32 v9, v23 offset:256
    ds_read_b32 v10, v23 offset:512
    ds_read_b32 v11, v23 offset:768
    ds_read_b32 v12, v23 offset:1024
    ds_read_b32 v13, v23 offset:1280
    ds_read_b32 v14, v23 offset:1536
    ds_read_b32 v15, v23 offset:1792
    s_mov_b32 s44, s24
    s_mov_b32 s45, s25
    s_mov_b32 s46, 2048
    s_mov_b32 s47, 0x20000
    s_waitcnt lgkmcnt(0)
    v_add_f32 v8, v8, v9
    v_add_f32 v10, v10, v11
    v_add_f32 v12, v12, v13
    v_add_f32 v14, v14, v15
    v_add_f32 v8, v8, v10
    v_add_f32 v12, v12, v14
    v_add_f32 v8, v8, v12
    v_mov_b32 v9, v8
    s_nop 1
    v_permlane32_swap_b32 v8, v9
    v_mul_f32 v10, 0xbfb8aa3b, v9
    v_exp_f32 v10, v10
    s_nop 0
    v_add_f32 v10, 1.0, v10
    v_rcp_f32 v10, v10
    s_nop 0
    v_mul_f32 v9, v9, v10
    v_lshlrev_b32 v22, 16, v24
    v_fma_f32 v8, v8, v9, v22
    v_cvt_pk_bf16_f32 v8, v8, v8
    s_cmp_eq_u32 s59, 0
    s_cbranch_scc1 Lfin_done13
    s_mov_b32 exec_hi, 0
    buffer_store_short v8, v27, s[44:47], s55 offen
    s_mov_b64 exec, -1
    s_cmp_lg_u32 s50, 0
    s_cbranch_scc1 Lfin_done13
    s_add_u32 s48, s28, 229376
    s_addc_u32 s49, s29, 0
    s_mov_b32 s50, 64
    s_mov_b32 s51, 0x20000
    v_mov_b32 v8, s3
    v_mov_b32 v9, 0
    s_mov_b64 exec, 1
    buffer_store_dword v8, v9, s[48:51], 0 offen sc1
    s_mov_b64 exec, -1
Lfin_done13:
    s_cmp_eq_u32 s59, 0
    s_cbranch_scc1 Lfreal10
Latt_end:
Lend:
    s_endpgm
.section .rodata,"a"
.p2align 6
.amdhsa_kernel recurrent_scan__compressed_kv_cla__glu_gated_reglu__decode_kernel
  .amdhsa_next_free_vgpr 256
  .amdhsa_next_free_sgpr 102
  .amdhsa_accum_offset 256
  .amdhsa_group_segment_fixed_size 0
  .amdhsa_kernarg_size 104
  .amdhsa_user_sgpr_count 2
  .amdhsa_user_sgpr_kernarg_segment_ptr 1
  .amdhsa_system_sgpr_workgroup_id_x 1
.end_amdhsa_kernel
```
